```python
import torch

def _softmax(x, axis=-1):
    return torch.softmax(x, dim=axis)
def _gelu(x):
    return torch.nn.functional.gelu(x, approximate="tanh")
def _silu(x):
    return torch.nn.functional.silu(x)
def _sigmoid(x):
    return torch.sigmoid(x)
def _layernorm(x, axis=-1, eps=1e-5):
    m = x.mean(dim=axis, keepdim=True)
    v = x.var(dim=axis, keepdim=True, unbiased=False)
    return (x - m) / torch.sqrt(v + eps)
def _scatter_add(tgt, idx, src, axis=0):
    return tgt.clone().index_add_(axis, idx, src)
def _segment_sum(src, seg, n):
    out = torch.zeros((n,) + src.shape[1:], dtype=src.dtype)
    return out.index_add_(0, seg, src)
def _pad(x, pw):
    flat = tuple(v for pair in reversed(pw) for v in pair)
    return torch.nn.functional.pad(x, flat)

kernel_name = 'gated_mix__gqa_block_cached__gqa_block_cached__decode'

def setup_inputs():

    _w = (lambda a: (lambda t: t.to(torch.bfloat16) if t.is_floating_point() else t)(torch.as_tensor(a)))
    def _A_setup():
        B, Sq, D = 1, 1, 640
        Hq, Hkv, Sk, Dh = 32, 32, 16384, 128
        assert Hq % Hkv == 0, (Hq, Hkv)
        return {
            "x": _w((lambda *s: torch.randn(*s, dtype=torch.bfloat16) * 0.05)(B, Sq, D)),
            "k_cache": _w((lambda *s: torch.randn(*s, dtype=torch.bfloat16) * 3.2)(B, Hkv, Sk, Dh)),
            "v_cache": _w((lambda *s: torch.randn(*s, dtype=torch.bfloat16) * 0.05)(B, Hkv, Sk, Dh)),
            "wq": _w((lambda *s: torch.randn(*s, dtype=torch.bfloat16) * 3.2)(D, Hq * Dh) * (D ** -0.5)),
            "wo": _w((lambda *s: torch.randn(*s, dtype=torch.bfloat16) * 0.05)(Hq * Dh, D) * ((Hq * Dh) ** -0.5)),
        }
    _A_in = _A_setup()

    def _B_setup():
        B, Sq, D = 1, 1, 640
        Hq, Hkv, Sk, Dh = 32, 32, 16384, 128
        assert Hq % Hkv == 0, (Hq, Hkv)
        return {
            "x": _w((lambda *s: torch.randn(*s, dtype=torch.bfloat16) * 0.05)(B, Sq, D)),
            "k_cache": _w((lambda *s: torch.randn(*s, dtype=torch.bfloat16) * 3.2)(B, Hkv, Sk, Dh)),
            "v_cache": _w((lambda *s: torch.randn(*s, dtype=torch.bfloat16) * 0.05)(B, Hkv, Sk, Dh)),
            "wq": _w((lambda *s: torch.randn(*s, dtype=torch.bfloat16) * 3.2)(D, Hq * Dh) * (D ** -0.5)),
            "wo": _w((lambda *s: torch.randn(*s, dtype=torch.bfloat16) * 0.05)(Hq * Dh, D) * ((Hq * Dh) ** -0.5)),
        }
    _B_in = _B_setup()

    return {
        "A_x": _A_in["x"],
        "A_k_cache": _A_in["k_cache"],
        "A_v_cache": _A_in["v_cache"],
        "A_wq": _A_in["wq"],
        "A_wo": _A_in["wo"],
        "B_x": _B_in["x"],
        "B_k_cache": _B_in["k_cache"],
        "B_v_cache": _B_in["v_cache"],
        "B_wq": _B_in["wq"],
        "B_wo": _B_in["wo"],
        "gate_w": _w((lambda *s: torch.randn(*s, dtype=torch.bfloat16) * 0.05)(640) * 16.0),
    }

def reference(A_x, A_k_cache, A_v_cache, A_wq, A_wo, B_x, B_k_cache, B_v_cache, B_wq, B_wo, gate_w):
    def _A_ref(x, k_cache, v_cache, wq, wo):
        B, Sq, D = x.shape
        Hq, Dh = 32, 128
        Hkv = k_cache.shape[1]
        rep = Hq // Hkv
        q = (lambda x, *d: x.permute(*d))((x @ wq).reshape(B, Sq, Hq, Dh), 0, 2, 1, 3)
        k = (lambda x, n, axis: torch.repeat_interleave(x, n, dim=axis))(k_cache, rep, axis=1)
        v = (lambda x, n, axis: torch.repeat_interleave(x, n, dim=axis))(v_cache, rep, axis=1)
        scores = torch.einsum("bhqd,bhkd->bhqk", q, k) * (Dh ** -0.5)
        p = _softmax(scores, axis=-1)
        o = torch.einsum("bhqk,bhkd->bhqd", p, v)
        return (lambda x, *d: x.permute(*d))(o, 0, 2, 1, 3).reshape(B, Sq, Hq * Dh) @ wo

    def _B_ref(x, k_cache, v_cache, wq, wo):
        B, Sq, D = x.shape
        Hq, Dh = 32, 128
        Hkv = k_cache.shape[1]
        rep = Hq // Hkv
        q = (lambda x, *d: x.permute(*d))((x @ wq).reshape(B, Sq, Hq, Dh), 0, 2, 1, 3)
        k = (lambda x, n, axis: torch.repeat_interleave(x, n, dim=axis))(k_cache, rep, axis=1)
        v = (lambda x, n, axis: torch.repeat_interleave(x, n, dim=axis))(v_cache, rep, axis=1)
        scores = torch.einsum("bhqd,bhkd->bhqk", q, k) * (Dh ** -0.5)
        p = _softmax(scores, axis=-1)
        o = torch.einsum("bhqk,bhkd->bhqd", p, v)
        return (lambda x, *d: x.permute(*d))(o, 0, 2, 1, 3).reshape(B, Sq, Hq * Dh) @ wo

    x = A_x
    g = _sigmoid((x * gate_w).sum(-1, keepdims=True))
    a = _A_ref(x, A_k_cache, A_v_cache, A_wq, A_wo)
    b = _B_ref(x, B_k_cache, B_v_cache, B_wq, B_wo)
    return g * a + (1 - g) * b
```

```asm
; @launch grid=(256,1,1) block=(512,1,1) lds=41984
.amdgcn_target "amdgcn-amd-amdhsa--gfx950"
.text
  .globl gated_mix__gqa_block_cached__gqa_block_cached__decode_kernel
  .p2align 8
  .type gated_mix__gqa_block_cached__gqa_block_cached__decode_kernel,@function
gated_mix__gqa_block_cached__gqa_block_cached__decode_kernel:
  s_cmp_ge_u32 s2, 256
  s_cbranch_scc1 L_end
  v_cmp_gt_u32 vcc, 448, v0
  s_cbranch_vccnz L_ld
  v_mov_b32 v4, 12
  v_mov_b32 v5, 0
  v_mov_b32 v6, 0
  v_mov_b32 v7, 0
  v_mov_b32 v9, -1
  ds_write_b128 v5, v[4:7] offset:0
  ds_write_b64 v5, v[6:7] offset:16
  ds_write_b64 v5, v[6:7] offset:24
  ds_write_b32 v5, v9 offset:128
  s_waitcnt lgkmcnt(0)
L_ld:
  s_load_dwordx8 s[8:15], s[0:1], 8
  s_load_dwordx8 s[16:23], s[0:1], 48
  s_load_dwordx2 s[4:5], s[0:1], 0
  s_load_dwordx8 s[24:31], s[0:1], 80
  v_lshrrev_b32 v1, 6, v0
  v_and_b32 v0, 63, v0
  v_readfirstlane_b32 s3, v1
  v_lshlrev_b32 v1, 4, v0
  s_and_b32 s72, s2, 7
  s_lshr_b32 s75, s2, 6
  s_lshl_b32 s75, s75, 3
  s_or_b32 s72, s72, s75
  s_bfe_u32 s73, s2, 0x30003
  s_barrier
  s_cmp_eq_u32 s3, 3
  s_cbranch_scc1 L_service
  s_cmp_ge_u32 s3, 4
  s_cbranch_scc1 L_helper
  s_setprio 3
  s_lshl_b32 s76, s72, 22
  s_and_b32 s77, s73, 3
  s_lshl_b32 s77, s77, 14
  s_add_u32 s76, s76, s77
  s_andn2_b32 s77, s73, 3
  s_lshl_b32 s77, s77, 19
  s_add_u32 s76, s76, s77
  s_lshr_b32 s75, s3, 1
  s_mul_i32 s75, s75, 49152
  s_lshl_b32 s79, s3, 13
  s_add_u32 s79, s79, s75
  s_mov_b32 s42, 8339456
  s_mov_b32 s43, 0x20000
  v_add_u32 v47, 4096, v1
  v_lshrrev_b32 v43, 2, v0
  v_lshlrev_b32 v43, 13, v43
  v_and_b32 v45, 3, v0
  v_lshl_add_u32 v43, v45, 6, v43
  v_lshlrev_b32 v45, 6, v0
  s_mul_i32 s77, s72, 163840
  s_mul_i32 s78, s73, 20480
  s_add_u32 s77, s77, s78
  s_lshl_b32 s78, s72, 8
  s_mul_i32 s61, s73, 655360
  s_add_u32 s78, s78, s61
  s_cmp_eq_u32 s3, 2
  s_cselect_b32 s61, s78, s77
  s_cselect_b32 s60, 32, 1
  s_cselect_b64 vcc, -1, 0
  s_lshl_b32 s60, s60, 12
  s_mov_b32 s58, 5242880
  s_mov_b32 s59, 0x20000
  v_cndmask_b32 v43, v45, v43, vcc
  s_waitcnt lgkmcnt(0)
  s_add_u32 s40, s8, s76
  s_addc_u32 s41, s9, 0
  s_cmp_eq_u32 s3, 0
  s_cselect_b64 s[56:57], s[14:15], s[22:23]
  s_cmp_eq_u32 s3, 2
  s_cselect_b64 s[56:57], s[20:21], s[56:57]
  v_mov_b32 v59, v43
  s_mov_b32 s62, s61
  buffer_load_dword v160, v59, s[56:59], s61 offen
  s_add_u32 s61, s61, s60
  buffer_load_dword v161, v59, s[56:59], s61 offen
  s_add_u32 s61, s61, s60
  buffer_load_dword v162, v59, s[56:59], s61 offen
  s_add_u32 s61, s61, s60
  s_add_u32 s44, s8, s76
  s_addc_u32 s45, s9, 0
  s_add_u32 s46, s10, s76
  s_addc_u32 s47, s11, 0
  s_sub_u32 s46, s46, 2097152
  s_subb_u32 s47, s47, 0
  s_add_u32 s48, s16, s76
  s_addc_u32 s49, s17, 0
  s_sub_u32 s48, s48, 4194304
  s_subb_u32 s49, s49, 0
  s_add_u32 s50, s18, s76
  s_addc_u32 s51, s19, 0
  s_sub_u32 s50, s50, 6291456
  s_subb_u32 s51, s51, 0
  v_and_b32 v43, 3, v0
  v_cmp_lt_u32 vcc, 1, v43
  v_mov_b32 v2, 0
  v_mov_b32 v7, 0xffff0000
  v_cndmask_b32 v2, v2, v7, vcc
  v_and_b32 v43, 1, v0
  v_cmp_eq_u32 vcc, 1, v43
  v_mov_b32 v3, 0x0c0c0302
  v_mov_b32 v7, 0x03020c0c
  v_cndmask_b32 v3, v3, v7, vcc
  v_mov_b32 v4, 0x3e0293ee
  v_mov_b32 v6, 0xff800000
  v_lshrrev_b32 v39, 2, v0
  v_lshlrev_b32 v39, 2, v39
  v_mov_b32 v40, 0
  v_mov_b32 v41, 1
  v_mov_b32 v43, 12
  s_mov_b32 s65, 1
  s_mov_b32 s66, 64
  s_mov_b32 s67, 128
  s_lshl_b32 s75, s3, 2
  v_mov_b32 v57, s75
  v_mov_b32 v44, 0
  v_mov_b32 v36, 0
  v_mov_b32 v20, 0
  v_mov_b32 v21, 0
  v_mov_b32 v22, 0
  v_mov_b32 v23, 0
  v_mov_b32 v24, 0
  v_mov_b32 v25, 0
  v_mov_b32 v26, 0
  v_mov_b32 v27, 0
  v_mov_b32 v28, 0
  v_mov_b32 v29, 0
  v_mov_b32 v30, 0
  v_mov_b32 v31, 0
  v_mov_b32 v32, 0
  v_mov_b32 v33, 0
  v_mov_b32 v34, 0
  v_mov_b32 v35, 0
  v_mov_b32 v16, 0
  v_mov_b32 v17, 0
  v_mov_b32 v18, 0
  v_mov_b32 v19, 0
  v_lshrrev_b32 v56, 4, v0
  v_lshlrev_b32 v56, 6, v56
  v_bfe_u32 v43, v0, 3, 1
  v_lshl_add_u32 v56, v43, 4, v56
  v_bfe_u32 v43, v0, 2, 1
  v_lshl_add_u32 v56, v43, 2, v56
  v_and_b32 v43, 1, v0
  v_lshl_add_u32 v56, v43, 1, v56
  v_bfe_u32 v43, v0, 1, 1
  v_mul_u32_u24 v43, 272, v43
  v_add_u32 v56, v56, v43
  s_mul_i32 s75, s3, 544
  v_add_u32 v56, s75, v56
  v_and_b32 v46, 15, v0
  v_lshlrev_b32 v46, 4, v46
  s_add_u32 s84, s3, 0
  s_add_u32 s85, s3, 3
  s_add_u32 s86, s3, 6
  s_add_u32 s87, s3, 9
  s_lshr_b32 s75, s3, 1
  s_mul_i32 s75, s75, 49152
  s_lshl_b32 s79, s3, 13
  s_add_u32 s79, s79, s75
  s_waitcnt vmcnt(2)
  buffer_load_dword v163, v59, s[56:59], s61 offen
  s_add_u32 s61, s61, s60
  s_waitcnt vmcnt(2)
  buffer_load_dword v164, v59, s[56:59], s61 offen
  s_add_u32 s61, s61, s60
  s_waitcnt vmcnt(1)
  buffer_load_dwordx4 v[64:67], v1, s[40:43], s79 offen offset:0 nt
  buffer_load_dwordx4 v[68:71], v1, s[40:43], s79 offen offset:1024 nt
  buffer_load_dwordx4 v[72:75], v1, s[40:43], s79 offen offset:2048 nt
  buffer_load_dwordx4 v[76:79], v1, s[40:43], s79 offen offset:3072 nt
  buffer_load_dwordx4 v[80:83], v47, s[40:43], s79 offen offset:0 nt
  buffer_load_dwordx4 v[84:87], v47, s[40:43], s79 offen offset:1024 nt
  buffer_load_dwordx4 v[88:91], v47, s[40:43], s79 offen offset:2048 nt
  buffer_load_dwordx4 v[92:95], v47, s[40:43], s79 offen offset:3072 nt
  s_lshr_b32 s75, s85, 1
  s_mul_i32 s75, s75, 49152
  s_lshl_b32 s79, s85, 13
  s_add_u32 s79, s79, s75
  s_waitcnt vmcnt(0)
  buffer_load_dwordx4 v[96:99], v1, s[40:43], s79 offen offset:0 nt
  buffer_load_dwordx4 v[100:103], v1, s[40:43], s79 offen offset:1024 nt
  buffer_load_dwordx4 v[104:107], v1, s[40:43], s79 offen offset:2048 nt
  buffer_load_dwordx4 v[108:111], v1, s[40:43], s79 offen offset:3072 nt
  buffer_load_dwordx4 v[112:115], v47, s[40:43], s79 offen offset:0 nt
  buffer_load_dwordx4 v[116:119], v47, s[40:43], s79 offen offset:1024 nt
  buffer_load_dwordx4 v[120:123], v47, s[40:43], s79 offen offset:2048 nt
  buffer_load_dwordx4 v[124:127], v47, s[40:43], s79 offen offset:3072 nt
  s_lshr_b32 s75, s86, 1
  s_mul_i32 s75, s75, 49152
  s_lshl_b32 s79, s86, 13
  s_add_u32 s79, s79, s75
  s_waitcnt vmcnt(0)
  buffer_load_dwordx4 v[128:131], v1, s[40:43], s79 offen offset:0 nt
  buffer_load_dwordx4 v[132:135], v1, s[40:43], s79 offen offset:1024 nt
  buffer_load_dwordx4 v[136:139], v1, s[40:43], s79 offen offset:2048 nt
  buffer_load_dwordx4 v[140:143], v1, s[40:43], s79 offen offset:3072 nt
  buffer_load_dwordx4 v[144:147], v47, s[40:43], s79 offen offset:0 nt
  buffer_load_dwordx4 v[148:151], v47, s[40:43], s79 offen offset:1024 nt
  buffer_load_dwordx4 v[152:155], v47, s[40:43], s79 offen offset:2048 nt
  buffer_load_dwordx4 v[156:159], v47, s[40:43], s79 offen offset:3072 nt
  s_lshr_b32 s75, s87, 1
  s_mul_i32 s75, s75, 49152
  s_lshl_b32 s79, s87, 13
  s_add_u32 s79, s79, s75
  s_waitcnt vmcnt(0)
  buffer_load_dwordx4 v[160:163], v1, s[40:43], s79 offen offset:0 nt
  buffer_load_dwordx4 v[164:167], v1, s[40:43], s79 offen offset:1024 nt
  buffer_load_dwordx4 v[168:171], v1, s[40:43], s79 offen offset:2048 nt
  buffer_load_dwordx4 v[172:175], v1, s[40:43], s79 offen offset:3072 nt
  buffer_load_dwordx4 v[176:179], v47, s[40:43], s79 offen offset:0 nt
  buffer_load_dwordx4 v[180:183], v47, s[40:43], s79 offen offset:1024 nt
  buffer_load_dwordx4 v[184:187], v47, s[40:43], s79 offen offset:2048 nt
  buffer_load_dwordx4 v[188:191], v47, s[40:43], s79 offen offset:3072 nt
L_gqa:
  ds_read_b32 v58, v40 offset:16
  ds_read_b128 v[8:11], v46 offset:256
  s_waitcnt lgkmcnt(0)
  v_readfirstlane_b32 s75, v58
  s_cmp_eq_u32 s75, 0
  s_cbranch_scc1 L_gqa
  v_dot2_f32_bf16 v12, v64, v8, 0
  v_dot2_f32_bf16 v14, v72, v8, 0
  v_dot2_f32_bf16 v13, v68, v8, 0
  v_dot2_f32_bf16 v15, v76, v8, 0
  v_dot2_f32_bf16 v12, v65, v9, v12
  v_dot2_f32_bf16 v14, v73, v9, v14
  v_dot2_f32_bf16 v13, v69, v9, v13
  v_dot2_f32_bf16 v15, v77, v9, v15
  v_dot2_f32_bf16 v12, v66, v10, v12
  v_dot2_f32_bf16 v14, v74, v10, v14
  v_dot2_f32_bf16 v13, v70, v10, v13
  v_dot2_f32_bf16 v15, v78, v10, v15
  v_dot2_f32_bf16 v12, v67, v11, v12
  v_dot2_f32_bf16 v14, v75, v11, v14
  v_dot2_f32_bf16 v13, v71, v11, v13
  v_dot2_f32_bf16 v15, v79, v11, v15
  s_lshl_b32 s75, s84, 7
  v_add_u32 v43, s75, v39
  s_nop 0
  v_add_f32_dpp v12, v12, v12 row_ror:8 row_mask:0xf bank_mask:0x3
  v_add_f32_dpp v12, v14, v14 row_ror:8 row_mask:0xf bank_mask:0xc
  v_add_f32_dpp v13, v13, v13 row_ror:8 row_mask:0xf bank_mask:0x3
  v_add_f32_dpp v13, v15, v15 row_ror:8 row_mask:0xf bank_mask:0xc
  v_add_f32_dpp v12, v12, v12 row_half_mirror row_mask:0xf bank_mask:0x5
  s_nop 0
  v_add_f32_dpp v12, v13, v13 row_half_mirror row_mask:0xf bank_mask:0xa
  s_nop 1
  v_add_f32_dpp v12, v12, v12 quad_perm:[1,0,3,2] row_mask:0xf bank_mask:0xf
  s_nop 1
  v_add_f32_dpp v12, v12, v12 quad_perm:[2,3,0,1] row_mask:0xf bank_mask:0xf
  v_max_f32 v6, v6, v12
  ds_write_b32 v43, v12 offset:25600
  v_dot2_f32_bf16 v12, v80, v8, 0
  v_dot2_f32_bf16 v14, v88, v8, 0
  v_dot2_f32_bf16 v13, v84, v8, 0
  v_dot2_f32_bf16 v15, v92, v8, 0
  v_dot2_f32_bf16 v12, v81, v9, v12
  v_dot2_f32_bf16 v14, v89, v9, v14
  v_dot2_f32_bf16 v13, v85, v9, v13
  v_dot2_f32_bf16 v15, v93, v9, v15
  v_dot2_f32_bf16 v12, v82, v10, v12
  v_dot2_f32_bf16 v14, v90, v10, v14
  v_dot2_f32_bf16 v13, v86, v10, v13
  v_dot2_f32_bf16 v15, v94, v10, v15
  v_dot2_f32_bf16 v12, v83, v11, v12
  v_dot2_f32_bf16 v14, v91, v11, v14
  v_dot2_f32_bf16 v13, v87, v11, v13
  v_dot2_f32_bf16 v15, v95, v11, v15
  s_nop 2
  v_add_f32_dpp v12, v12, v12 row_ror:8 row_mask:0xf bank_mask:0x3
  v_add_f32_dpp v12, v14, v14 row_ror:8 row_mask:0xf bank_mask:0xc
  v_add_f32_dpp v13, v13, v13 row_ror:8 row_mask:0xf bank_mask:0x3
  v_add_f32_dpp v13, v15, v15 row_ror:8 row_mask:0xf bank_mask:0xc
  v_add_f32_dpp v12, v12, v12 row_half_mirror row_mask:0xf bank_mask:0x5
  s_nop 0
  v_add_f32_dpp v12, v13, v13 row_half_mirror row_mask:0xf bank_mask:0xa
  s_nop 1
  v_add_f32_dpp v12, v12, v12 quad_perm:[1,0,3,2] row_mask:0xf bank_mask:0xf
  s_nop 1
  v_add_f32_dpp v12, v12, v12 quad_perm:[2,3,0,1] row_mask:0xf bank_mask:0xf
  v_max_f32 v6, v6, v12
  ds_write_b32 v43, v12 offset:25664
  s_waitcnt vmcnt(0)
  s_mov_b64 exec, 1
  ds_add_rtn_u32 v42, v40, v41 offset:0
  ds_read_b32 v58, v40 offset:4
  s_mov_b64 exec, -1
  s_waitcnt lgkmcnt(0)
  v_readfirstlane_b32 s84, v42
  v_readfirstlane_b32 s64, v58
  s_cmp_lt_u32 s84, 128
  s_cselect_b64 s[52:53], s[44:45], s[48:49]
  s_cselect_b64 s[54:55], s[46:47], s[50:51]
  s_bitcmp1_b32 s84, 6
  s_cselect_b64 s[40:41], s[54:55], s[52:53]
  s_lshr_b32 s75, s84, 1
  s_mul_i32 s75, s75, 49152
  s_lshl_b32 s79, s84, 13
  s_add_u32 s79, s79, s75
  buffer_load_dwordx4 v[64:67], v1, s[40:43], s79 offen offset:0 nt
  buffer_load_dwordx4 v[68:71], v1, s[40:43], s79 offen offset:1024 nt
  buffer_load_dwordx4 v[72:75], v1, s[40:43], s79 offen offset:2048 nt
  buffer_load_dwordx4 v[76:79], v1, s[40:43], s79 offen offset:3072 nt
  buffer_load_dwordx4 v[80:83], v47, s[40:43], s79 offen offset:0 nt
  buffer_load_dwordx4 v[84:87], v47, s[40:43], s79 offen offset:1024 nt
  buffer_load_dwordx4 v[88:91], v47, s[40:43], s79 offen offset:2048 nt
  buffer_load_dwordx4 v[92:95], v47, s[40:43], s79 offen offset:3072 nt
  v_dot2_f32_bf16 v12, v96, v8, 0
  v_dot2_f32_bf16 v14, v104, v8, 0
  v_dot2_f32_bf16 v13, v100, v8, 0
  v_dot2_f32_bf16 v15, v108, v8, 0
  v_dot2_f32_bf16 v12, v97, v9, v12
  v_dot2_f32_bf16 v14, v105, v9, v14
  v_dot2_f32_bf16 v13, v101, v9, v13
  v_dot2_f32_bf16 v15, v109, v9, v15
  v_dot2_f32_bf16 v12, v98, v10, v12
  v_dot2_f32_bf16 v14, v106, v10, v14
  v_dot2_f32_bf16 v13, v102, v10, v13
  v_dot2_f32_bf16 v15, v110, v10, v15
  v_dot2_f32_bf16 v12, v99, v11, v12
  v_dot2_f32_bf16 v14, v107, v11, v14
  v_dot2_f32_bf16 v13, v103, v11, v13
  v_dot2_f32_bf16 v15, v111, v11, v15
  s_lshl_b32 s75, s85, 7
  v_add_u32 v43, s75, v39
  s_nop 0
  v_add_f32_dpp v12, v12, v12 row_ror:8 row_mask:0xf bank_mask:0x3
  v_add_f32_dpp v12, v14, v14 row_ror:8 row_mask:0xf bank_mask:0xc
  v_add_f32_dpp v13, v13, v13 row_ror:8 row_mask:0xf bank_mask:0x3
  v_add_f32_dpp v13, v15, v15 row_ror:8 row_mask:0xf bank_mask:0xc
  v_add_f32_dpp v12, v12, v12 row_half_mirror row_mask:0xf bank_mask:0x5
  s_nop 0
  v_add_f32_dpp v12, v13, v13 row_half_mirror row_mask:0xf bank_mask:0xa
  s_nop 1
  v_add_f32_dpp v12, v12, v12 quad_perm:[1,0,3,2] row_mask:0xf bank_mask:0xf
  s_nop 1
  v_add_f32_dpp v12, v12, v12 quad_perm:[2,3,0,1] row_mask:0xf bank_mask:0xf
  v_max_f32 v6, v6, v12
  ds_write_b32 v43, v12 offset:25600
  v_dot2_f32_bf16 v12, v112, v8, 0
  v_dot2_f32_bf16 v14, v120, v8, 0
  v_dot2_f32_bf16 v13, v116, v8, 0
  v_dot2_f32_bf16 v15, v124, v8, 0
  v_dot2_f32_bf16 v12, v113, v9, v12
  v_dot2_f32_bf16 v14, v121, v9, v14
  v_dot2_f32_bf16 v13, v117, v9, v13
  v_dot2_f32_bf16 v15, v125, v9, v15
  v_dot2_f32_bf16 v12, v114, v10, v12
  v_dot2_f32_bf16 v14, v122, v10, v14
  v_dot2_f32_bf16 v13, v118, v10, v13
  v_dot2_f32_bf16 v15, v126, v10, v15
  v_dot2_f32_bf16 v12, v115, v11, v12
  v_dot2_f32_bf16 v14, v123, v11, v14
  v_dot2_f32_bf16 v13, v119, v11, v13
  v_dot2_f32_bf16 v15, v127, v11, v15
  s_nop 2
  v_add_f32_dpp v12, v12, v12 row_ror:8 row_mask:0xf bank_mask:0x3
  v_add_f32_dpp v12, v14, v14 row_ror:8 row_mask:0xf bank_mask:0xc
  v_add_f32_dpp v13, v13, v13 row_ror:8 row_mask:0xf bank_mask:0x3
  v_add_f32_dpp v13, v15, v15 row_ror:8 row_mask:0xf bank_mask:0xc
  v_add_f32_dpp v12, v12, v12 row_half_mirror row_mask:0xf bank_mask:0x5
  s_nop 0
  v_add_f32_dpp v12, v13, v13 row_half_mirror row_mask:0xf bank_mask:0xa
  s_nop 1
  v_add_f32_dpp v12, v12, v12 quad_perm:[1,0,3,2] row_mask:0xf bank_mask:0xf
  s_nop 1
  v_add_f32_dpp v12, v12, v12 quad_perm:[2,3,0,1] row_mask:0xf bank_mask:0xf
  v_max_f32 v6, v6, v12
  ds_write_b32 v43, v12 offset:25664
  s_mov_b64 exec, 1
  ds_add_rtn_u32 v42, v40, v41 offset:0
  ds_read_b32 v58, v40 offset:4
  s_mov_b64 exec, -1
  s_waitcnt lgkmcnt(0)
  v_readfirstlane_b32 s85, v42
  v_readfirstlane_b32 s64, v58
  s_cmp_lt_u32 s85, 128
  s_cselect_b64 s[52:53], s[44:45], s[48:49]
  s_cselect_b64 s[54:55], s[46:47], s[50:51]
  s_bitcmp1_b32 s85, 6
  s_cselect_b64 s[40:41], s[54:55], s[52:53]
  s_lshr_b32 s75, s85, 1
  s_mul_i32 s75, s75, 49152
  s_lshl_b32 s79, s85, 13
  s_add_u32 s79, s79, s75
  buffer_load_dwordx4 v[96:99], v1, s[40:43], s79 offen offset:0 nt
  buffer_load_dwordx4 v[100:103], v1, s[40:43], s79 offen offset:1024 nt
  buffer_load_dwordx4 v[104:107], v1, s[40:43], s79 offen offset:2048 nt
  buffer_load_dwordx4 v[108:111], v1, s[40:43], s79 offen offset:3072 nt
  buffer_load_dwordx4 v[112:115], v47, s[40:43], s79 offen offset:0 nt
  buffer_load_dwordx4 v[116:119], v47, s[40:43], s79 offen offset:1024 nt
  buffer_load_dwordx4 v[120:123], v47, s[40:43], s79 offen offset:2048 nt
  buffer_load_dwordx4 v[124:127], v47, s[40:43], s79 offen offset:3072 nt
  s_mov_b32 s65, 2
  v_dot2_f32_bf16 v12, v128, v8, 0
  v_dot2_f32_bf16 v14, v136, v8, 0
  v_dot2_f32_bf16 v13, v132, v8, 0
  v_dot2_f32_bf16 v15, v140, v8, 0
  v_dot2_f32_bf16 v12, v129, v9, v12
  v_dot2_f32_bf16 v14, v137, v9, v14
  v_dot2_f32_bf16 v13, v133, v9, v13
  v_dot2_f32_bf16 v15, v141, v9, v15
  v_dot2_f32_bf16 v12, v130, v10, v12
  v_dot2_f32_bf16 v14, v138, v10, v14
  v_dot2_f32_bf16 v13, v134, v10, v13
  v_dot2_f32_bf16 v15, v142, v10, v15
  v_dot2_f32_bf16 v12, v131, v11, v12
  v_dot2_f32_bf16 v14, v139, v11, v14
  v_dot2_f32_bf16 v13, v135, v11, v13
  v_dot2_f32_bf16 v15, v143, v11, v15
  s_lshl_b32 s75, s86, 7
  v_add_u32 v43, s75, v39
  s_nop 0
  v_add_f32_dpp v12, v12, v12 row_ror:8 row_mask:0xf bank_mask:0x3
  v_add_f32_dpp v12, v14, v14 row_ror:8 row_mask:0xf bank_mask:0xc
  v_add_f32_dpp v13, v13, v13 row_ror:8 row_mask:0xf bank_mask:0x3
  v_add_f32_dpp v13, v15, v15 row_ror:8 row_mask:0xf bank_mask:0xc
  v_add_f32_dpp v12, v12, v12 row_half_mirror row_mask:0xf bank_mask:0x5
  s_nop 0
  v_add_f32_dpp v12, v13, v13 row_half_mirror row_mask:0xf bank_mask:0xa
  s_nop 1
  v_add_f32_dpp v12, v12, v12 quad_perm:[1,0,3,2] row_mask:0xf bank_mask:0xf
  s_nop 1
  v_add_f32_dpp v12, v12, v12 quad_perm:[2,3,0,1] row_mask:0xf bank_mask:0xf
  v_max_f32 v6, v6, v12
  ds_write_b32 v43, v12 offset:25600
  v_dot2_f32_bf16 v12, v144, v8, 0
  v_dot2_f32_bf16 v14, v152, v8, 0
  v_dot2_f32_bf16 v13, v148, v8, 0
  v_dot2_f32_bf16 v15, v156, v8, 0
  v_dot2_f32_bf16 v12, v145, v9, v12
  v_dot2_f32_bf16 v14, v153, v9, v14
  v_dot2_f32_bf16 v13, v149, v9, v13
  v_dot2_f32_bf16 v15, v157, v9, v15
  v_dot2_f32_bf16 v12, v146, v10, v12
  v_dot2_f32_bf16 v14, v154, v10, v14
  v_dot2_f32_bf16 v13, v150, v10, v13
  v_dot2_f32_bf16 v15, v158, v10, v15
  v_dot2_f32_bf16 v12, v147, v11, v12
  v_dot2_f32_bf16 v14, v155, v11, v14
  v_dot2_f32_bf16 v13, v151, v11, v13
  v_dot2_f32_bf16 v15, v159, v11, v15
  s_nop 2
  v_add_f32_dpp v12, v12, v12 row_ror:8 row_mask:0xf bank_mask:0x3
  v_add_f32_dpp v12, v14, v14 row_ror:8 row_mask:0xf bank_mask:0xc
  v_add_f32_dpp v13, v13, v13 row_ror:8 row_mask:0xf bank_mask:0x3
  v_add_f32_dpp v13, v15, v15 row_ror:8 row_mask:0xf bank_mask:0xc
  v_add_f32_dpp v12, v12, v12 row_half_mirror row_mask:0xf bank_mask:0x5
  s_nop 0
  v_add_f32_dpp v12, v13, v13 row_half_mirror row_mask:0xf bank_mask:0xa
  s_nop 1
  v_add_f32_dpp v12, v12, v12 quad_perm:[1,0,3,2] row_mask:0xf bank_mask:0xf
  s_nop 1
  v_add_f32_dpp v12, v12, v12 quad_perm:[2,3,0,1] row_mask:0xf bank_mask:0xf
  v_max_f32 v6, v6, v12
  ds_write_b32 v43, v12 offset:25664
  v_dot2_f32_bf16 v12, v160, v8, 0
  v_dot2_f32_bf16 v14, v168, v8, 0
  v_dot2_f32_bf16 v13, v164, v8, 0
  v_dot2_f32_bf16 v15, v172, v8, 0
  v_dot2_f32_bf16 v12, v161, v9, v12
  v_dot2_f32_bf16 v14, v169, v9, v14
  v_dot2_f32_bf16 v13, v165, v9, v13
  v_dot2_f32_bf16 v15, v173, v9, v15
  v_dot2_f32_bf16 v12, v162, v10, v12
  v_dot2_f32_bf16 v14, v170, v10, v14
  v_dot2_f32_bf16 v13, v166, v10, v13
  v_dot2_f32_bf16 v15, v174, v10, v15
  v_dot2_f32_bf16 v12, v163, v11, v12
  v_dot2_f32_bf16 v14, v171, v11, v14
  v_dot2_f32_bf16 v13, v167, v11, v13
  v_dot2_f32_bf16 v15, v175, v11, v15
  s_lshl_b32 s75, s87, 7
  v_add_u32 v43, s75, v39
  s_nop 0
  v_add_f32_dpp v12, v12, v12 row_ror:8 row_mask:0xf bank_mask:0x3
  v_add_f32_dpp v12, v14, v14 row_ror:8 row_mask:0xf bank_mask:0xc
  v_add_f32_dpp v13, v13, v13 row_ror:8 row_mask:0xf bank_mask:0x3
  v_add_f32_dpp v13, v15, v15 row_ror:8 row_mask:0xf bank_mask:0xc
  v_add_f32_dpp v12, v12, v12 row_half_mirror row_mask:0xf bank_mask:0x5
  s_nop 0
  v_add_f32_dpp v12, v13, v13 row_half_mirror row_mask:0xf bank_mask:0xa
  s_nop 1
  v_add_f32_dpp v12, v12, v12 quad_perm:[1,0,3,2] row_mask:0xf bank_mask:0xf
  s_nop 1
  v_add_f32_dpp v12, v12, v12 quad_perm:[2,3,0,1] row_mask:0xf bank_mask:0xf
  v_max_f32 v6, v6, v12
  ds_write_b32 v43, v12 offset:25600
  v_dot2_f32_bf16 v12, v176, v8, 0
  v_dot2_f32_bf16 v14, v184, v8, 0
  v_dot2_f32_bf16 v13, v180, v8, 0
  v_dot2_f32_bf16 v15, v188, v8, 0
  v_dot2_f32_bf16 v12, v177, v9, v12
  v_dot2_f32_bf16 v14, v185, v9, v14
  v_dot2_f32_bf16 v13, v181, v9, v13
  v_dot2_f32_bf16 v15, v189, v9, v15
  v_dot2_f32_bf16 v12, v178, v10, v12
  v_dot2_f32_bf16 v14, v186, v10, v14
  v_dot2_f32_bf16 v13, v182, v10, v13
  v_dot2_f32_bf16 v15, v190, v10, v15
  v_dot2_f32_bf16 v12, v179, v11, v12
  v_dot2_f32_bf16 v14, v187, v11, v14
  v_dot2_f32_bf16 v13, v183, v11, v13
  v_dot2_f32_bf16 v15, v191, v11, v15
  s_nop 2
  v_add_f32_dpp v12, v12, v12 row_ror:8 row_mask:0xf bank_mask:0x3
  v_add_f32_dpp v12, v14, v14 row_ror:8 row_mask:0xf bank_mask:0xc
  v_add_f32_dpp v13, v13, v13 row_ror:8 row_mask:0xf bank_mask:0x3
  v_add_f32_dpp v13, v15, v15 row_ror:8 row_mask:0xf bank_mask:0xc
  v_add_f32_dpp v12, v12, v12 row_half_mirror row_mask:0xf bank_mask:0x5
  s_nop 0
  v_add_f32_dpp v12, v13, v13 row_half_mirror row_mask:0xf bank_mask:0xa
  s_nop 1
  v_add_f32_dpp v12, v12, v12 quad_perm:[1,0,3,2] row_mask:0xf bank_mask:0xf
  s_nop 1
  v_add_f32_dpp v12, v12, v12 quad_perm:[2,3,0,1] row_mask:0xf bank_mask:0xf
  v_max_f32 v6, v6, v12
  ds_write_b32 v43, v12 offset:25664
  v_mov_b32 v240, 0
  v_mov_b32 v241, 0
  v_mov_b32 v242, 0
  v_mov_b32 v243, 0
  v_mov_b32 v244, 0
  v_mov_b32 v245, 0
  v_mov_b32 v246, 0
  v_mov_b32 v247, 0
  v_mov_b32 v248, 0
  v_mov_b32 v249, 0
  v_mov_b32 v250, 0
  v_mov_b32 v251, 0
  v_mov_b32 v252, 0
  v_mov_b32 v253, 0
  v_mov_b32 v254, 0
  v_mov_b32 v255, 0
  .p2align 5
L_k0:
  s_cmp_ge_u32 s84, s66
  s_cbranch_scc1 L_tr0
  s_cmp_eq_u32 s65, 1
  s_cbranch_scc1 L_d1k0
  s_waitcnt vmcnt(8)
  v_dot2_f32_bf16 v12, v64, v8, 0
  v_dot2_f32_bf16 v14, v72, v8, 0
  v_dot2_f32_bf16 v13, v68, v8, 0
  v_dot2_f32_bf16 v15, v76, v8, 0
  v_dot2_f32_bf16 v12, v65, v9, v12
  v_dot2_f32_bf16 v14, v73, v9, v14
  v_dot2_f32_bf16 v13, v69, v9, v13
  v_dot2_f32_bf16 v15, v77, v9, v15
  v_dot2_f32_bf16 v12, v66, v10, v12
  v_dot2_f32_bf16 v14, v74, v10, v14
  v_dot2_f32_bf16 v13, v70, v10, v13
  v_dot2_f32_bf16 v15, v78, v10, v15
  v_dot2_f32_bf16 v12, v67, v11, v12
  v_dot2_f32_bf16 v14, v75, v11, v14
  v_dot2_f32_bf16 v13, v71, v11, v13
  v_dot2_f32_bf16 v15, v79, v11, v15
  s_lshl_b32 s75, s84, 7
  v_add_u32 v43, s75, v39
  s_nop 0
  v_add_f32_dpp v12, v12, v12 row_ror:8 row_mask:0xf bank_mask:0x3
  v_add_f32_dpp v12, v14, v14 row_ror:8 row_mask:0xf bank_mask:0xc
  v_add_f32_dpp v13, v13, v13 row_ror:8 row_mask:0xf bank_mask:0x3
  v_add_f32_dpp v13, v15, v15 row_ror:8 row_mask:0xf bank_mask:0xc
  v_add_f32_dpp v12, v12, v12 row_half_mirror row_mask:0xf bank_mask:0x5
  s_nop 0
  v_add_f32_dpp v12, v13, v13 row_half_mirror row_mask:0xf bank_mask:0xa
  s_nop 1
  v_add_f32_dpp v12, v12, v12 quad_perm:[1,0,3,2] row_mask:0xf bank_mask:0xf
  s_nop 1
  v_add_f32_dpp v12, v12, v12 quad_perm:[2,3,0,1] row_mask:0xf bank_mask:0xf
  v_max_f32 v6, v6, v12
  ds_write_b32 v43, v12 offset:25600
  s_branch L_d2k0
L_d1k0:
  s_waitcnt vmcnt(0)
  s_mov_b64 exec, 1
  ds_add_rtn_u32 v42, v40, v41 offset:0
  ds_read_b32 v58, v40 offset:4
  s_mov_b64 exec, -1
  v_dot2_f32_bf16 v12, v64, v8, 0
  v_dot2_f32_bf16 v14, v72, v8, 0
  v_dot2_f32_bf16 v13, v68, v8, 0
  v_dot2_f32_bf16 v15, v76, v8, 0
  v_dot2_f32_bf16 v12, v65, v9, v12
  v_dot2_f32_bf16 v14, v73, v9, v14
  v_dot2_f32_bf16 v13, v69, v9, v13
  v_dot2_f32_bf16 v15, v77, v9, v15
  v_dot2_f32_bf16 v12, v66, v10, v12
  v_dot2_f32_bf16 v14, v74, v10, v14
  v_dot2_f32_bf16 v13, v70, v10, v13
  v_dot2_f32_bf16 v15, v78, v10, v15
  v_dot2_f32_bf16 v12, v67, v11, v12
  v_dot2_f32_bf16 v14, v75, v11, v14
  v_dot2_f32_bf16 v13, v71, v11, v13
  v_dot2_f32_bf16 v15, v79, v11, v15
  s_lshl_b32 s75, s84, 7
  v_add_u32 v43, s75, v39
  s_nop 0
  v_add_f32_dpp v12, v12, v12 row_ror:8 row_mask:0xf bank_mask:0x3
  v_add_f32_dpp v12, v14, v14 row_ror:8 row_mask:0xf bank_mask:0xc
  v_add_f32_dpp v13, v13, v13 row_ror:8 row_mask:0xf bank_mask:0x3
  v_add_f32_dpp v13, v15, v15 row_ror:8 row_mask:0xf bank_mask:0xc
  v_add_f32_dpp v12, v12, v12 row_half_mirror row_mask:0xf bank_mask:0x5
  s_nop 0
  v_add_f32_dpp v12, v13, v13 row_half_mirror row_mask:0xf bank_mask:0xa
  s_nop 1
  v_add_f32_dpp v12, v12, v12 quad_perm:[1,0,3,2] row_mask:0xf bank_mask:0xf
  s_nop 1
  v_add_f32_dpp v12, v12, v12 quad_perm:[2,3,0,1] row_mask:0xf bank_mask:0xf
  v_max_f32 v6, v6, v12
  ds_write_b32 v43, v12 offset:25600
  s_waitcnt lgkmcnt(0)
  v_readfirstlane_b32 s85, v42
  v_readfirstlane_b32 s64, v58
  s_cmp_lt_u32 s85, 128
  s_cselect_b64 s[52:53], s[44:45], s[48:49]
  s_cselect_b64 s[54:55], s[46:47], s[50:51]
  s_bitcmp1_b32 s85, 6
  s_cselect_b64 s[40:41], s[54:55], s[52:53]
  s_lshr_b32 s75, s85, 1
  s_mul_i32 s75, s75, 49152
  s_lshl_b32 s79, s85, 13
  s_add_u32 s79, s79, s75
  buffer_load_dwordx4 v[96:99], v1, s[40:43], s79 offen offset:0 nt
  buffer_load_dwordx4 v[100:103], v1, s[40:43], s79 offen offset:1024 nt
  buffer_load_dwordx4 v[104:107], v1, s[40:43], s79 offen offset:2048 nt
  buffer_load_dwordx4 v[108:111], v1, s[40:43], s79 offen offset:3072 nt
  buffer_load_dwordx4 v[112:115], v47, s[40:43], s79 offen offset:0 nt
  buffer_load_dwordx4 v[116:119], v47, s[40:43], s79 offen offset:1024 nt
  buffer_load_dwordx4 v[120:123], v47, s[40:43], s79 offen offset:2048 nt
  buffer_load_dwordx4 v[124:127], v47, s[40:43], s79 offen offset:3072 nt
L_d2k0:
  s_mov_b32 s65, 1
  s_cmp_le_u32 s64, s3
  s_cbranch_scc1 L_d3k0
  s_mov_b64 exec, 1
  ds_add_rtn_u32 v42, v40, v41 offset:0
  ds_read_b32 v58, v40 offset:4
  s_mov_b64 exec, -1
  s_waitcnt lgkmcnt(0)
  v_readfirstlane_b32 s86, v42
  v_readfirstlane_b32 s64, v58
  s_cmp_lt_u32 s86, 128
  s_cselect_b64 s[52:53], s[44:45], s[48:49]
  s_cselect_b64 s[54:55], s[46:47], s[50:51]
  s_bitcmp1_b32 s86, 6
  s_cselect_b64 s[40:41], s[54:55], s[52:53]
  s_lshr_b32 s75, s86, 1
  s_mul_i32 s75, s75, 49152
  s_lshl_b32 s79, s86, 13
  s_add_u32 s79, s79, s75
  buffer_load_dwordx4 v[128:131], v1, s[40:43], s79 offen offset:0 nt
  buffer_load_dwordx4 v[132:135], v1, s[40:43], s79 offen offset:1024 nt
  buffer_load_dwordx4 v[136:139], v1, s[40:43], s79 offen offset:2048 nt
  buffer_load_dwordx4 v[140:143], v1, s[40:43], s79 offen offset:3072 nt
  buffer_load_dwordx4 v[144:147], v47, s[40:43], s79 offen offset:0 nt
  buffer_load_dwordx4 v[148:151], v47, s[40:43], s79 offen offset:1024 nt
  buffer_load_dwordx4 v[152:155], v47, s[40:43], s79 offen offset:2048 nt
  buffer_load_dwordx4 v[156:159], v47, s[40:43], s79 offen offset:3072 nt
  s_mov_b32 s65, 2
L_d3k0:
  v_dot2_f32_bf16 v12, v80, v8, 0
  v_dot2_f32_bf16 v14, v88, v8, 0
  v_dot2_f32_bf16 v13, v84, v8, 0
  v_dot2_f32_bf16 v15, v92, v8, 0
  v_dot2_f32_bf16 v12, v81, v9, v12
  v_dot2_f32_bf16 v14, v89, v9, v14
  v_dot2_f32_bf16 v13, v85, v9, v13
  v_dot2_f32_bf16 v15, v93, v9, v15
  v_dot2_f32_bf16 v12, v82, v10, v12
  v_dot2_f32_bf16 v14, v90, v10, v14
  v_dot2_f32_bf16 v13, v86, v10, v13
  v_dot2_f32_bf16 v15, v94, v10, v15
  v_dot2_f32_bf16 v12, v83, v11, v12
  v_dot2_f32_bf16 v14, v91, v11, v14
  v_dot2_f32_bf16 v13, v87, v11, v13
  v_dot2_f32_bf16 v15, v95, v11, v15
  s_nop 2
  v_add_f32_dpp v12, v12, v12 row_ror:8 row_mask:0xf bank_mask:0x3
  v_add_f32_dpp v12, v14, v14 row_ror:8 row_mask:0xf bank_mask:0xc
  v_add_f32_dpp v13, v13, v13 row_ror:8 row_mask:0xf bank_mask:0x3
  v_add_f32_dpp v13, v15, v15 row_ror:8 row_mask:0xf bank_mask:0xc
  v_add_f32_dpp v12, v12, v12 row_half_mirror row_mask:0xf bank_mask:0x5
  s_nop 0
  v_add_f32_dpp v12, v13, v13 row_half_mirror row_mask:0xf bank_mask:0xa
  s_nop 1
  v_add_f32_dpp v12, v12, v12 quad_perm:[1,0,3,2] row_mask:0xf bank_mask:0xf
  s_nop 1
  v_add_f32_dpp v12, v12, v12 quad_perm:[2,3,0,1] row_mask:0xf bank_mask:0xf
  v_max_f32 v6, v6, v12
  ds_write_b32 v43, v12 offset:25664
L_k1:
  s_cmp_ge_u32 s85, s66
  s_cbranch_scc1 L_tr1
  s_cmp_eq_u32 s65, 1
  s_cbranch_scc1 L_d1k1
  s_waitcnt vmcnt(8)
  v_dot2_f32_bf16 v12, v96, v8, 0
  v_dot2_f32_bf16 v14, v104, v8, 0
  v_dot2_f32_bf16 v13, v100, v8, 0
  v_dot2_f32_bf16 v15, v108, v8, 0
  v_dot2_f32_bf16 v12, v97, v9, v12
  v_dot2_f32_bf16 v14, v105, v9, v14
  v_dot2_f32_bf16 v13, v101, v9, v13
  v_dot2_f32_bf16 v15, v109, v9, v15
  v_dot2_f32_bf16 v12, v98, v10, v12
  v_dot2_f32_bf16 v14, v106, v10, v14
  v_dot2_f32_bf16 v13, v102, v10, v13
  v_dot2_f32_bf16 v15, v110, v10, v15
  v_dot2_f32_bf16 v12, v99, v11, v12
  v_dot2_f32_bf16 v14, v107, v11, v14
  v_dot2_f32_bf16 v13, v103, v11, v13
  v_dot2_f32_bf16 v15, v111, v11, v15
  s_lshl_b32 s75, s85, 7
  v_add_u32 v43, s75, v39
  s_nop 0
  v_add_f32_dpp v12, v12, v12 row_ror:8 row_mask:0xf bank_mask:0x3
  v_add_f32_dpp v12, v14, v14 row_ror:8 row_mask:0xf bank_mask:0xc
  v_add_f32_dpp v13, v13, v13 row_ror:8 row_mask:0xf bank_mask:0x3
  v_add_f32_dpp v13, v15, v15 row_ror:8 row_mask:0xf bank_mask:0xc
  v_add_f32_dpp v12, v12, v12 row_half_mirror row_mask:0xf bank_mask:0x5
  s_nop 0
  v_add_f32_dpp v12, v13, v13 row_half_mirror row_mask:0xf bank_mask:0xa
  s_nop 1
  v_add_f32_dpp v12, v12, v12 quad_perm:[1,0,3,2] row_mask:0xf bank_mask:0xf
  s_nop 1
  v_add_f32_dpp v12, v12, v12 quad_perm:[2,3,0,1] row_mask:0xf bank_mask:0xf
  v_max_f32 v6, v6, v12
  ds_write_b32 v43, v12 offset:25600
  s_branch L_d2k1
L_d1k1:
  s_waitcnt vmcnt(0)
  s_mov_b64 exec, 1
  ds_add_rtn_u32 v42, v40, v41 offset:0
  ds_read_b32 v58, v40 offset:4
  s_mov_b64 exec, -1
  v_dot2_f32_bf16 v12, v96, v8, 0
  v_dot2_f32_bf16 v14, v104, v8, 0
  v_dot2_f32_bf16 v13, v100, v8, 0
  v_dot2_f32_bf16 v15, v108, v8, 0
  v_dot2_f32_bf16 v12, v97, v9, v12
  v_dot2_f32_bf16 v14, v105, v9, v14
  v_dot2_f32_bf16 v13, v101, v9, v13
  v_dot2_f32_bf16 v15, v109, v9, v15
  v_dot2_f32_bf16 v12, v98, v10, v12
  v_dot2_f32_bf16 v14, v106, v10, v14
  v_dot2_f32_bf16 v13, v102, v10, v13
  v_dot2_f32_bf16 v15, v110, v10, v15
  v_dot2_f32_bf16 v12, v99, v11, v12
  v_dot2_f32_bf16 v14, v107, v11, v14
  v_dot2_f32_bf16 v13, v103, v11, v13
  v_dot2_f32_bf16 v15, v111, v11, v15
  s_lshl_b32 s75, s85, 7
  v_add_u32 v43, s75, v39
  s_nop 0
  v_add_f32_dpp v12, v12, v12 row_ror:8 row_mask:0xf bank_mask:0x3
  v_add_f32_dpp v12, v14, v14 row_ror:8 row_mask:0xf bank_mask:0xc
  v_add_f32_dpp v13, v13, v13 row_ror:8 row_mask:0xf bank_mask:0x3
  v_add_f32_dpp v13, v15, v15 row_ror:8 row_mask:0xf bank_mask:0xc
  v_add_f32_dpp v12, v12, v12 row_half_mirror row_mask:0xf bank_mask:0x5
  s_nop 0
  v_add_f32_dpp v12, v13, v13 row_half_mirror row_mask:0xf bank_mask:0xa
  s_nop 1
  v_add_f32_dpp v12, v12, v12 quad_perm:[1,0,3,2] row_mask:0xf bank_mask:0xf
  s_nop 1
  v_add_f32_dpp v12, v12, v12 quad_perm:[2,3,0,1] row_mask:0xf bank_mask:0xf
  v_max_f32 v6, v6, v12
  ds_write_b32 v43, v12 offset:25600
  s_waitcnt lgkmcnt(0)
  v_readfirstlane_b32 s86, v42
  v_readfirstlane_b32 s64, v58
  s_cmp_lt_u32 s86, 128
  s_cselect_b64 s[52:53], s[44:45], s[48:49]
  s_cselect_b64 s[54:55], s[46:47], s[50:51]
  s_bitcmp1_b32 s86, 6
  s_cselect_b64 s[40:41], s[54:55], s[52:53]
  s_lshr_b32 s75, s86, 1
  s_mul_i32 s75, s75, 49152
  s_lshl_b32 s79, s86, 13
  s_add_u32 s79, s79, s75
  buffer_load_dwordx4 v[128:131], v1, s[40:43], s79 offen offset:0 nt
  buffer_load_dwordx4 v[132:135], v1, s[40:43], s79 offen offset:1024 nt
  buffer_load_dwordx4 v[136:139], v1, s[40:43], s79 offen offset:2048 nt
  buffer_load_dwordx4 v[140:143], v1, s[40:43], s79 offen offset:3072 nt
  buffer_load_dwordx4 v[144:147], v47, s[40:43], s79 offen offset:0 nt
  buffer_load_dwordx4 v[148:151], v47, s[40:43], s79 offen offset:1024 nt
  buffer_load_dwordx4 v[152:155], v47, s[40:43], s79 offen offset:2048 nt
  buffer_load_dwordx4 v[156:159], v47, s[40:43], s79 offen offset:3072 nt
L_d2k1:
  s_mov_b32 s65, 1
  s_cmp_le_u32 s64, s3
  s_cbranch_scc1 L_d3k1
  s_mov_b64 exec, 1
  ds_add_rtn_u32 v42, v40, v41 offset:0
  ds_read_b32 v58, v40 offset:4
  s_mov_b64 exec, -1
  s_waitcnt lgkmcnt(0)
  v_readfirstlane_b32 s84, v42
  v_readfirstlane_b32 s64, v58
  s_cmp_lt_u32 s84, 128
  s_cselect_b64 s[52:53], s[44:45], s[48:49]
  s_cselect_b64 s[54:55], s[46:47], s[50:51]
  s_bitcmp1_b32 s84, 6
  s_cselect_b64 s[40:41], s[54:55], s[52:53]
  s_lshr_b32 s75, s84, 1
  s_mul_i32 s75, s75, 49152
  s_lshl_b32 s79, s84, 13
  s_add_u32 s79, s79, s75
  buffer_load_dwordx4 v[64:67], v1, s[40:43], s79 offen offset:0 nt
  buffer_load_dwordx4 v[68:71], v1, s[40:43], s79 offen offset:1024 nt
  buffer_load_dwordx4 v[72:75], v1, s[40:43], s79 offen offset:2048 nt
  buffer_load_dwordx4 v[76:79], v1, s[40:43], s79 offen offset:3072 nt
  buffer_load_dwordx4 v[80:83], v47, s[40:43], s79 offen offset:0 nt
  buffer_load_dwordx4 v[84:87], v47, s[40:43], s79 offen offset:1024 nt
  buffer_load_dwordx4 v[88:91], v47, s[40:43], s79 offen offset:2048 nt
  buffer_load_dwordx4 v[92:95], v47, s[40:43], s79 offen offset:3072 nt
  s_mov_b32 s65, 2
L_d3k1:
  v_dot2_f32_bf16 v12, v112, v8, 0
  v_dot2_f32_bf16 v14, v120, v8, 0
  v_dot2_f32_bf16 v13, v116, v8, 0
  v_dot2_f32_bf16 v15, v124, v8, 0
  v_dot2_f32_bf16 v12, v113, v9, v12
  v_dot2_f32_bf16 v14, v121, v9, v14
  v_dot2_f32_bf16 v13, v117, v9, v13
  v_dot2_f32_bf16 v15, v125, v9, v15
  v_dot2_f32_bf16 v12, v114, v10, v12
  v_dot2_f32_bf16 v14, v122, v10, v14
  v_dot2_f32_bf16 v13, v118, v10, v13
  v_dot2_f32_bf16 v15, v126, v10, v15
  v_dot2_f32_bf16 v12, v115, v11, v12
  v_dot2_f32_bf16 v14, v123, v11, v14
  v_dot2_f32_bf16 v13, v119, v11, v13
  v_dot2_f32_bf16 v15, v127, v11, v15
  s_nop 2
  v_add_f32_dpp v12, v12, v12 row_ror:8 row_mask:0xf bank_mask:0x3
  v_add_f32_dpp v12, v14, v14 row_ror:8 row_mask:0xf bank_mask:0xc
  v_add_f32_dpp v13, v13, v13 row_ror:8 row_mask:0xf bank_mask:0x3
  v_add_f32_dpp v13, v15, v15 row_ror:8 row_mask:0xf bank_mask:0xc
  v_add_f32_dpp v12, v12, v12 row_half_mirror row_mask:0xf bank_mask:0x5
  s_nop 0
  v_add_f32_dpp v12, v13, v13 row_half_mirror row_mask:0xf bank_mask:0xa
  s_nop 1
  v_add_f32_dpp v12, v12, v12 quad_perm:[1,0,3,2] row_mask:0xf bank_mask:0xf
  s_nop 1
  v_add_f32_dpp v12, v12, v12 quad_perm:[2,3,0,1] row_mask:0xf bank_mask:0xf
  v_max_f32 v6, v6, v12
  ds_write_b32 v43, v12 offset:25664
L_k2:
  s_cmp_ge_u32 s86, s66
  s_cbranch_scc1 L_tr2
  s_cmp_eq_u32 s65, 1
  s_cbranch_scc1 L_d1k2
  s_waitcnt vmcnt(8)
  v_dot2_f32_bf16 v12, v128, v8, 0
  v_dot2_f32_bf16 v14, v136, v8, 0
  v_dot2_f32_bf16 v13, v132, v8, 0
  v_dot2_f32_bf16 v15, v140, v8, 0
  v_dot2_f32_bf16 v12, v129, v9, v12
  v_dot2_f32_bf16 v14, v137, v9, v14
  v_dot2_f32_bf16 v13, v133, v9, v13
  v_dot2_f32_bf16 v15, v141, v9, v15
  v_dot2_f32_bf16 v12, v130, v10, v12
  v_dot2_f32_bf16 v14, v138, v10, v14
  v_dot2_f32_bf16 v13, v134, v10, v13
  v_dot2_f32_bf16 v15, v142, v10, v15
  v_dot2_f32_bf16 v12, v131, v11, v12
  v_dot2_f32_bf16 v14, v139, v11, v14
  v_dot2_f32_bf16 v13, v135, v11, v13
  v_dot2_f32_bf16 v15, v143, v11, v15
  s_lshl_b32 s75, s86, 7
  v_add_u32 v43, s75, v39
  s_nop 0
  v_add_f32_dpp v12, v12, v12 row_ror:8 row_mask:0xf bank_mask:0x3
  v_add_f32_dpp v12, v14, v14 row_ror:8 row_mask:0xf bank_mask:0xc
  v_add_f32_dpp v13, v13, v13 row_ror:8 row_mask:0xf bank_mask:0x3
  v_add_f32_dpp v13, v15, v15 row_ror:8 row_mask:0xf bank_mask:0xc
  v_add_f32_dpp v12, v12, v12 row_half_mirror row_mask:0xf bank_mask:0x5
  s_nop 0
  v_add_f32_dpp v12, v13, v13 row_half_mirror row_mask:0xf bank_mask:0xa
  s_nop 1
  v_add_f32_dpp v12, v12, v12 quad_perm:[1,0,3,2] row_mask:0xf bank_mask:0xf
  s_nop 1
  v_add_f32_dpp v12, v12, v12 quad_perm:[2,3,0,1] row_mask:0xf bank_mask:0xf
  v_max_f32 v6, v6, v12
  ds_write_b32 v43, v12 offset:25600
  s_branch L_d2k2
L_d1k2:
  s_waitcnt vmcnt(0)
  s_mov_b64 exec, 1
  ds_add_rtn_u32 v42, v40, v41 offset:0
  ds_read_b32 v58, v40 offset:4
  s_mov_b64 exec, -1
  v_dot2_f32_bf16 v12, v128, v8, 0
  v_dot2_f32_bf16 v14, v136, v8, 0
  v_dot2_f32_bf16 v13, v132, v8, 0
  v_dot2_f32_bf16 v15, v140, v8, 0
  v_dot2_f32_bf16 v12, v129, v9, v12
  v_dot2_f32_bf16 v14, v137, v9, v14
  v_dot2_f32_bf16 v13, v133, v9, v13
  v_dot2_f32_bf16 v15, v141, v9, v15
  v_dot2_f32_bf16 v12, v130, v10, v12
  v_dot2_f32_bf16 v14, v138, v10, v14
  v_dot2_f32_bf16 v13, v134, v10, v13
  v_dot2_f32_bf16 v15, v142, v10, v15
  v_dot2_f32_bf16 v12, v131, v11, v12
  v_dot2_f32_bf16 v14, v139, v11, v14
  v_dot2_f32_bf16 v13, v135, v11, v13
  v_dot2_f32_bf16 v15, v143, v11, v15
  s_lshl_b32 s75, s86, 7
  v_add_u32 v43, s75, v39
  s_nop 0
  v_add_f32_dpp v12, v12, v12 row_ror:8 row_mask:0xf bank_mask:0x3
  v_add_f32_dpp v12, v14, v14 row_ror:8 row_mask:0xf bank_mask:0xc
  v_add_f32_dpp v13, v13, v13 row_ror:8 row_mask:0xf bank_mask:0x3
  v_add_f32_dpp v13, v15, v15 row_ror:8 row_mask:0xf bank_mask:0xc
  v_add_f32_dpp v12, v12, v12 row_half_mirror row_mask:0xf bank_mask:0x5
  s_nop 0
  v_add_f32_dpp v12, v13, v13 row_half_mirror row_mask:0xf bank_mask:0xa
  s_nop 1
  v_add_f32_dpp v12, v12, v12 quad_perm:[1,0,3,2] row_mask:0xf bank_mask:0xf
  s_nop 1
  v_add_f32_dpp v12, v12, v12 quad_perm:[2,3,0,1] row_mask:0xf bank_mask:0xf
  v_max_f32 v6, v6, v12
  ds_write_b32 v43, v12 offset:25600
  s_waitcnt lgkmcnt(0)
  v_readfirstlane_b32 s84, v42
  v_readfirstlane_b32 s64, v58
  s_cmp_lt_u32 s84, 128
  s_cselect_b64 s[52:53], s[44:45], s[48:49]
  s_cselect_b64 s[54:55], s[46:47], s[50:51]
  s_bitcmp1_b32 s84, 6
  s_cselect_b64 s[40:41], s[54:55], s[52:53]
  s_lshr_b32 s75, s84, 1
  s_mul_i32 s75, s75, 49152
  s_lshl_b32 s79, s84, 13
  s_add_u32 s79, s79, s75
  buffer_load_dwordx4 v[64:67], v1, s[40:43], s79 offen offset:0 nt
  buffer_load_dwordx4 v[68:71], v1, s[40:43], s79 offen offset:1024 nt
  buffer_load_dwordx4 v[72:75], v1, s[40:43], s79 offen offset:2048 nt
  buffer_load_dwordx4 v[76:79], v1, s[40:43], s79 offen offset:3072 nt
  buffer_load_dwordx4 v[80:83], v47, s[40:43], s79 offen offset:0 nt
  buffer_load_dwordx4 v[84:87], v47, s[40:43], s79 offen offset:1024 nt
  buffer_load_dwordx4 v[88:91], v47, s[40:43], s79 offen offset:2048 nt
  buffer_load_dwordx4 v[92:95], v47, s[40:43], s79 offen offset:3072 nt
L_d2k2:
  s_mov_b32 s65, 1
  s_cmp_le_u32 s64, s3
  s_cbranch_scc1 L_d3k2
  s_mov_b64 exec, 1
  ds_add_rtn_u32 v42, v40, v41 offset:0
  ds_read_b32 v58, v40 offset:4
  s_mov_b64 exec, -1
  s_waitcnt lgkmcnt(0)
  v_readfirstlane_b32 s85, v42
  v_readfirstlane_b32 s64, v58
  s_cmp_lt_u32 s85, 128
  s_cselect_b64 s[52:53], s[44:45], s[48:49]
  s_cselect_b64 s[54:55], s[46:47], s[50:51]
  s_bitcmp1_b32 s85, 6
  s_cselect_b64 s[40:41], s[54:55], s[52:53]
  s_lshr_b32 s75, s85, 1
  s_mul_i32 s75, s75, 49152
  s_lshl_b32 s79, s85, 13
  s_add_u32 s79, s79, s75
  buffer_load_dwordx4 v[96:99], v1, s[40:43], s79 offen offset:0 nt
  buffer_load_dwordx4 v[100:103], v1, s[40:43], s79 offen offset:1024 nt
  buffer_load_dwordx4 v[104:107], v1, s[40:43], s79 offen offset:2048 nt
  buffer_load_dwordx4 v[108:111], v1, s[40:43], s79 offen offset:3072 nt
  buffer_load_dwordx4 v[112:115], v47, s[40:43], s79 offen offset:0 nt
  buffer_load_dwordx4 v[116:119], v47, s[40:43], s79 offen offset:1024 nt
  buffer_load_dwordx4 v[120:123], v47, s[40:43], s79 offen offset:2048 nt
  buffer_load_dwordx4 v[124:127], v47, s[40:43], s79 offen offset:3072 nt
  s_mov_b32 s65, 2
L_d3k2:
  v_dot2_f32_bf16 v12, v144, v8, 0
  v_dot2_f32_bf16 v14, v152, v8, 0
  v_dot2_f32_bf16 v13, v148, v8, 0
  v_dot2_f32_bf16 v15, v156, v8, 0
  v_dot2_f32_bf16 v12, v145, v9, v12
  v_dot2_f32_bf16 v14, v153, v9, v14
  v_dot2_f32_bf16 v13, v149, v9, v13
  v_dot2_f32_bf16 v15, v157, v9, v15
  v_dot2_f32_bf16 v12, v146, v10, v12
  v_dot2_f32_bf16 v14, v154, v10, v14
  v_dot2_f32_bf16 v13, v150, v10, v13
  v_dot2_f32_bf16 v15, v158, v10, v15
  v_dot2_f32_bf16 v12, v147, v11, v12
  v_dot2_f32_bf16 v14, v155, v11, v14
  v_dot2_f32_bf16 v13, v151, v11, v13
  v_dot2_f32_bf16 v15, v159, v11, v15
  s_nop 2
  v_add_f32_dpp v12, v12, v12 row_ror:8 row_mask:0xf bank_mask:0x3
  v_add_f32_dpp v12, v14, v14 row_ror:8 row_mask:0xf bank_mask:0xc
  v_add_f32_dpp v13, v13, v13 row_ror:8 row_mask:0xf bank_mask:0x3
  v_add_f32_dpp v13, v15, v15 row_ror:8 row_mask:0xf bank_mask:0xc
  v_add_f32_dpp v12, v12, v12 row_half_mirror row_mask:0xf bank_mask:0x5
  s_nop 0
  v_add_f32_dpp v12, v13, v13 row_half_mirror row_mask:0xf bank_mask:0xa
  s_nop 1
  v_add_f32_dpp v12, v12, v12 quad_perm:[1,0,3,2] row_mask:0xf bank_mask:0xf
  s_nop 1
  v_add_f32_dpp v12, v12, v12 quad_perm:[2,3,0,1] row_mask:0xf bank_mask:0xf
  v_max_f32 v6, v6, v12
  ds_write_b32 v43, v12 offset:25664
  s_branch L_k0
L_tr0:
  s_nop 1
  v_max_f32_dpp v6, v6, v6 quad_perm:[1,0,3,2] row_mask:0xf bank_mask:0xf
  s_nop 1
  v_max_f32_dpp v6, v6, v6 quad_perm:[2,3,0,1] row_mask:0xf bank_mask:0xf
  s_nop 1
  v_max_f32_dpp v6, v6, v6 row_half_mirror row_mask:0xf bank_mask:0xf
  s_nop 1
  v_max_f32_dpp v6, v6, v6 row_mirror row_mask:0xf bank_mask:0xf
  s_nop 1
  v_max_f32_dpp v6, v6, v6 row_bcast:15 row_mask:0xa bank_mask:0xf
  s_nop 1
  v_max_f32_dpp v6, v6, v6 row_bcast:31 row_mask:0xc bank_mask:0xf
  s_mov_b32 exec_lo, 0
  s_mov_b32 exec_hi, 0x80000000
  ds_write_b32 v57, v6 offset:64
  ds_add_u32 v36, v41 offset:24
  s_mov_b64 exec, -1
  v_subrev_u32 v39, 8192, v39
  s_cmp_ge_u32 s84, s67
  s_cbranch_scc1 L_x0
  s_cmp_eq_u32 s65, 1
  s_cbranch_scc1 L_d1t0
  s_waitcnt vmcnt(8)
  s_branch L_d2t0
L_d1t0:
  s_waitcnt vmcnt(0)
  s_mov_b64 exec, 1
  ds_add_rtn_u32 v42, v40, v41 offset:0
  ds_read_b32 v58, v40 offset:4
  s_mov_b64 exec, -1
  s_waitcnt lgkmcnt(0)
  v_readfirstlane_b32 s85, v42
  v_readfirstlane_b32 s64, v58
  s_cmp_lt_u32 s85, 128
  s_cselect_b64 s[52:53], s[44:45], s[48:49]
  s_cselect_b64 s[54:55], s[46:47], s[50:51]
  s_bitcmp1_b32 s85, 6
  s_cselect_b64 s[40:41], s[54:55], s[52:53]
  s_lshr_b32 s75, s85, 1
  s_mul_i32 s75, s75, 49152
  s_lshl_b32 s79, s85, 13
  s_add_u32 s79, s79, s75
  buffer_load_dwordx4 v[96:99], v1, s[40:43], s79 offen offset:0 nt
  buffer_load_dwordx4 v[100:103], v1, s[40:43], s79 offen offset:1024 nt
  buffer_load_dwordx4 v[104:107], v1, s[40:43], s79 offen offset:2048 nt
  buffer_load_dwordx4 v[108:111], v1, s[40:43], s79 offen offset:3072 nt
  buffer_load_dwordx4 v[112:115], v47, s[40:43], s79 offen offset:0 nt
  buffer_load_dwordx4 v[116:119], v47, s[40:43], s79 offen offset:1024 nt
  buffer_load_dwordx4 v[120:123], v47, s[40:43], s79 offen offset:2048 nt
  buffer_load_dwordx4 v[124:127], v47, s[40:43], s79 offen offset:3072 nt
L_d2t0:
  s_mov_b32 s65, 1
  s_cmp_le_u32 s64, s3
  s_cbranch_scc1 L_d3t0
  s_mov_b64 exec, 1
  ds_add_rtn_u32 v42, v40, v41 offset:0
  ds_read_b32 v58, v40 offset:4
  s_mov_b64 exec, -1
  s_waitcnt lgkmcnt(0)
  v_readfirstlane_b32 s86, v42
  v_readfirstlane_b32 s64, v58
  s_cmp_lt_u32 s86, 128
  s_cselect_b64 s[52:53], s[44:45], s[48:49]
  s_cselect_b64 s[54:55], s[46:47], s[50:51]
  s_bitcmp1_b32 s86, 6
  s_cselect_b64 s[40:41], s[54:55], s[52:53]
  s_lshr_b32 s75, s86, 1
  s_mul_i32 s75, s75, 49152
  s_lshl_b32 s79, s86, 13
  s_add_u32 s79, s79, s75
  buffer_load_dwordx4 v[128:131], v1, s[40:43], s79 offen offset:0 nt
  buffer_load_dwordx4 v[132:135], v1, s[40:43], s79 offen offset:1024 nt
  buffer_load_dwordx4 v[136:139], v1, s[40:43], s79 offen offset:2048 nt
  buffer_load_dwordx4 v[140:143], v1, s[40:43], s79 offen offset:3072 nt
  buffer_load_dwordx4 v[144:147], v47, s[40:43], s79 offen offset:0 nt
  buffer_load_dwordx4 v[148:151], v47, s[40:43], s79 offen offset:1024 nt
  buffer_load_dwordx4 v[152:155], v47, s[40:43], s79 offen offset:2048 nt
  buffer_load_dwordx4 v[156:159], v47, s[40:43], s79 offen offset:3072 nt
  s_mov_b32 s65, 2
L_d3t0:
L_tw0:
  ds_read_b32 v58, v36 offset:24
  ds_read_b128 v[48:51], v44 offset:64
  s_waitcnt lgkmcnt(0)
  v_readfirstlane_b32 s75, v58
  s_cmp_lt_u32 s75, 3
  s_cbranch_scc1 L_tw0
  v_max3_f32 v48, v48, v49, v50
  v_mul_f32 v5, v48, v4
  v_sub_f32 v5, 0, v5
  s_lshl_b32 s75, s84, 7
  v_add_u32 v43, s75, v39
  ds_read_b32 v12, v43 offset:25600
  ds_read_b32 v13, v43 offset:25664
  s_waitcnt lgkmcnt(0)
  v_fma_f32 v12, v12, v4, v5
  v_fma_f32 v13, v13, v4, v5
  v_exp_f32 v12, v12
  v_exp_f32 v13, v13
  s_nop 0
  v_and_b32 v14, v12, v2
  v_and_b32 v15, v13, v2
  v_sub_f32 v12, v12, v14
  v_sub_f32 v13, v13, v15
  v_perm_b32 v12, v12, v12, v3
  v_perm_b32 v13, v13, v13, v3
  s_nop 1
  v_mov_b32_dpp v20, v12 quad_perm:[0,1,2,3] row_mask:0xf bank_mask:0x1
  v_mov_b32_dpp v21, v12 row_ror:4 row_mask:0xf bank_mask:0x2
  v_mov_b32_dpp v22, v12 row_ror:8 row_mask:0xf bank_mask:0x4
  v_mov_b32_dpp v23, v12 row_ror:12 row_mask:0xf bank_mask:0x8
  v_mov_b32_dpp v24, v12 row_ror:12 row_mask:0xf bank_mask:0x1
  v_mov_b32_dpp v25, v12 quad_perm:[0,1,2,3] row_mask:0xf bank_mask:0x2
  v_mov_b32_dpp v26, v12 row_ror:4 row_mask:0xf bank_mask:0x4
  v_mov_b32_dpp v27, v12 row_ror:8 row_mask:0xf bank_mask:0x8
  v_mov_b32_dpp v28, v12 row_ror:8 row_mask:0xf bank_mask:0x1
  v_mov_b32_dpp v29, v12 row_ror:12 row_mask:0xf bank_mask:0x2
  v_mov_b32_dpp v30, v12 quad_perm:[0,1,2,3] row_mask:0xf bank_mask:0x4
  v_mov_b32_dpp v31, v12 row_ror:4 row_mask:0xf bank_mask:0x8
  v_mov_b32_dpp v32, v12 row_ror:4 row_mask:0xf bank_mask:0x1
  v_mov_b32_dpp v33, v12 row_ror:8 row_mask:0xf bank_mask:0x2
  v_mov_b32_dpp v34, v12 row_ror:12 row_mask:0xf bank_mask:0x4
  v_mov_b32_dpp v35, v12 quad_perm:[0,1,2,3] row_mask:0xf bank_mask:0x8
  v_mov_b32_dpp v240, v13 quad_perm:[0,1,2,3] row_mask:0xf bank_mask:0x1
  v_mov_b32_dpp v241, v13 row_ror:4 row_mask:0xf bank_mask:0x2
  v_mov_b32_dpp v242, v13 row_ror:8 row_mask:0xf bank_mask:0x4
  v_mov_b32_dpp v243, v13 row_ror:12 row_mask:0xf bank_mask:0x8
  v_mov_b32_dpp v244, v13 row_ror:12 row_mask:0xf bank_mask:0x1
  v_mov_b32_dpp v245, v13 quad_perm:[0,1,2,3] row_mask:0xf bank_mask:0x2
  v_mov_b32_dpp v246, v13 row_ror:4 row_mask:0xf bank_mask:0x4
  v_mov_b32_dpp v247, v13 row_ror:8 row_mask:0xf bank_mask:0x8
  v_mov_b32_dpp v248, v13 row_ror:8 row_mask:0xf bank_mask:0x1
  v_mov_b32_dpp v249, v13 row_ror:12 row_mask:0xf bank_mask:0x2
  v_mov_b32_dpp v250, v13 quad_perm:[0,1,2,3] row_mask:0xf bank_mask:0x4
  v_mov_b32_dpp v251, v13 row_ror:4 row_mask:0xf bank_mask:0x8
  v_mov_b32_dpp v252, v13 row_ror:4 row_mask:0xf bank_mask:0x1
  v_mov_b32_dpp v253, v13 row_ror:8 row_mask:0xf bank_mask:0x2
  v_mov_b32_dpp v254, v13 row_ror:12 row_mask:0xf bank_mask:0x4
  v_mov_b32_dpp v255, v13 quad_perm:[0,1,2,3] row_mask:0xf bank_mask:0x8
  s_nop 1
  v_mfma_f32_16x16x32_bf16 v[16:19], v[64:67], v[20:23], v[16:19]
  v_mfma_f32_16x16x32_bf16 v[16:19], v[68:71], v[24:27], v[16:19]
  v_mfma_f32_16x16x32_bf16 v[16:19], v[72:75], v[28:31], v[16:19]
  v_mfma_f32_16x16x32_bf16 v[16:19], v[76:79], v[32:35], v[16:19]
  v_mfma_f32_16x16x32_bf16 v[16:19], v[80:83], v[240:243], v[16:19]
  v_mfma_f32_16x16x32_bf16 v[16:19], v[84:87], v[244:247], v[16:19]
  v_mfma_f32_16x16x32_bf16 v[16:19], v[88:91], v[248:251], v[16:19]
  v_mfma_f32_16x16x32_bf16 v[16:19], v[92:95], v[252:255], v[16:19]
  s_branch L_v1
L_tr1:
  s_nop 1
  v_max_f32_dpp v6, v6, v6 quad_perm:[1,0,3,2] row_mask:0xf bank_mask:0xf
  s_nop 1
  v_max_f32_dpp v6, v6, v6 quad_perm:[2,3,0,1] row_mask:0xf bank_mask:0xf
  s_nop 1
  v_max_f32_dpp v6, v6, v6 row_half_mirror row_mask:0xf bank_mask:0xf
  s_nop 1
  v_max_f32_dpp v6, v6, v6 row_mirror row_mask:0xf bank_mask:0xf
  s_nop 1
  v_max_f32_dpp v6, v6, v6 row_bcast:15 row_mask:0xa bank_mask:0xf
  s_nop 1
  v_max_f32_dpp v6, v6, v6 row_bcast:31 row_mask:0xc bank_mask:0xf
  s_mov_b32 exec_lo, 0
  s_mov_b32 exec_hi, 0x80000000
  ds_write_b32 v57, v6 offset:64
  ds_add_u32 v36, v41 offset:24
  s_mov_b64 exec, -1
  v_subrev_u32 v39, 8192, v39
  s_cmp_ge_u32 s85, s67
  s_cbranch_scc1 L_x1
  s_cmp_eq_u32 s65, 1
  s_cbranch_scc1 L_d1t1
  s_waitcnt vmcnt(8)
  s_branch L_d2t1
L_d1t1:
  s_waitcnt vmcnt(0)
  s_mov_b64 exec, 1
  ds_add_rtn_u32 v42, v40, v41 offset:0
  ds_read_b32 v58, v40 offset:4
  s_mov_b64 exec, -1
  s_waitcnt lgkmcnt(0)
  v_readfirstlane_b32 s86, v42
  v_readfirstlane_b32 s64, v58
  s_cmp_lt_u32 s86, 128
  s_cselect_b64 s[52:53], s[44:45], s[48:49]
  s_cselect_b64 s[54:55], s[46:47], s[50:51]
  s_bitcmp1_b32 s86, 6
  s_cselect_b64 s[40:41], s[54:55], s[52:53]
  s_lshr_b32 s75, s86, 1
  s_mul_i32 s75, s75, 49152
  s_lshl_b32 s79, s86, 13
  s_add_u32 s79, s79, s75
  buffer_load_dwordx4 v[128:131], v1, s[40:43], s79 offen offset:0 nt
  buffer_load_dwordx4 v[132:135], v1, s[40:43], s79 offen offset:1024 nt
  buffer_load_dwordx4 v[136:139], v1, s[40:43], s79 offen offset:2048 nt
  buffer_load_dwordx4 v[140:143], v1, s[40:43], s79 offen offset:3072 nt
  buffer_load_dwordx4 v[144:147], v47, s[40:43], s79 offen offset:0 nt
  buffer_load_dwordx4 v[148:151], v47, s[40:43], s79 offen offset:1024 nt
  buffer_load_dwordx4 v[152:155], v47, s[40:43], s79 offen offset:2048 nt
  buffer_load_dwordx4 v[156:159], v47, s[40:43], s79 offen offset:3072 nt
L_d2t1:
  s_mov_b32 s65, 1
  s_cmp_le_u32 s64, s3
  s_cbranch_scc1 L_d3t1
  s_mov_b64 exec, 1
  ds_add_rtn_u32 v42, v40, v41 offset:0
  ds_read_b32 v58, v40 offset:4
  s_mov_b64 exec, -1
  s_waitcnt lgkmcnt(0)
  v_readfirstlane_b32 s84, v42
  v_readfirstlane_b32 s64, v58
  s_cmp_lt_u32 s84, 128
  s_cselect_b64 s[52:53], s[44:45], s[48:49]
  s_cselect_b64 s[54:55], s[46:47], s[50:51]
  s_bitcmp1_b32 s84, 6
  s_cselect_b64 s[40:41], s[54:55], s[52:53]
  s_lshr_b32 s75, s84, 1
  s_mul_i32 s75, s75, 49152
  s_lshl_b32 s79, s84, 13
  s_add_u32 s79, s79, s75
  buffer_load_dwordx4 v[64:67], v1, s[40:43], s79 offen offset:0 nt
  buffer_load_dwordx4 v[68:71], v1, s[40:43], s79 offen offset:1024 nt
  buffer_load_dwordx4 v[72:75], v1, s[40:43], s79 offen offset:2048 nt
  buffer_load_dwordx4 v[76:79], v1, s[40:43], s79 offen offset:3072 nt
  buffer_load_dwordx4 v[80:83], v47, s[40:43], s79 offen offset:0 nt
  buffer_load_dwordx4 v[84:87], v47, s[40:43], s79 offen offset:1024 nt
  buffer_load_dwordx4 v[88:91], v47, s[40:43], s79 offen offset:2048 nt
  buffer_load_dwordx4 v[92:95], v47, s[40:43], s79 offen offset:3072 nt
  s_mov_b32 s65, 2
L_d3t1:
L_tw1:
  ds_read_b32 v58, v36 offset:24
  ds_read_b128 v[48:51], v44 offset:64
  s_waitcnt lgkmcnt(0)
  v_readfirstlane_b32 s75, v58
  s_cmp_lt_u32 s75, 3
  s_cbranch_scc1 L_tw1
  v_max3_f32 v48, v48, v49, v50
  v_mul_f32 v5, v48, v4
  v_sub_f32 v5, 0, v5
  s_lshl_b32 s75, s85, 7
  v_add_u32 v43, s75, v39
  ds_read_b32 v12, v43 offset:25600
  ds_read_b32 v13, v43 offset:25664
  s_waitcnt lgkmcnt(0)
  v_fma_f32 v12, v12, v4, v5
  v_fma_f32 v13, v13, v4, v5
  v_exp_f32 v12, v12
  v_exp_f32 v13, v13
  s_nop 0
  v_and_b32 v14, v12, v2
  v_and_b32 v15, v13, v2
  v_sub_f32 v12, v12, v14
  v_sub_f32 v13, v13, v15
  v_perm_b32 v12, v12, v12, v3
  v_perm_b32 v13, v13, v13, v3
  s_nop 1
  v_mov_b32_dpp v20, v12 quad_perm:[0,1,2,3] row_mask:0xf bank_mask:0x1
  v_mov_b32_dpp v21, v12 row_ror:4 row_mask:0xf bank_mask:0x2
  v_mov_b32_dpp v22, v12 row_ror:8 row_mask:0xf bank_mask:0x4
  v_mov_b32_dpp v23, v12 row_ror:12 row_mask:0xf bank_mask:0x8
  v_mov_b32_dpp v24, v12 row_ror:12 row_mask:0xf bank_mask:0x1
  v_mov_b32_dpp v25, v12 quad_perm:[0,1,2,3] row_mask:0xf bank_mask:0x2
  v_mov_b32_dpp v26, v12 row_ror:4 row_mask:0xf bank_mask:0x4
  v_mov_b32_dpp v27, v12 row_ror:8 row_mask:0xf bank_mask:0x8
  v_mov_b32_dpp v28, v12 row_ror:8 row_mask:0xf bank_mask:0x1
  v_mov_b32_dpp v29, v12 row_ror:12 row_mask:0xf bank_mask:0x2
  v_mov_b32_dpp v30, v12 quad_perm:[0,1,2,3] row_mask:0xf bank_mask:0x4
  v_mov_b32_dpp v31, v12 row_ror:4 row_mask:0xf bank_mask:0x8
  v_mov_b32_dpp v32, v12 row_ror:4 row_mask:0xf bank_mask:0x1
  v_mov_b32_dpp v33, v12 row_ror:8 row_mask:0xf bank_mask:0x2
  v_mov_b32_dpp v34, v12 row_ror:12 row_mask:0xf bank_mask:0x4
  v_mov_b32_dpp v35, v12 quad_perm:[0,1,2,3] row_mask:0xf bank_mask:0x8
  v_mov_b32_dpp v240, v13 quad_perm:[0,1,2,3] row_mask:0xf bank_mask:0x1
  v_mov_b32_dpp v241, v13 row_ror:4 row_mask:0xf bank_mask:0x2
  v_mov_b32_dpp v242, v13 row_ror:8 row_mask:0xf bank_mask:0x4
  v_mov_b32_dpp v243, v13 row_ror:12 row_mask:0xf bank_mask:0x8
  v_mov_b32_dpp v244, v13 row_ror:12 row_mask:0xf bank_mask:0x1
  v_mov_b32_dpp v245, v13 quad_perm:[0,1,2,3] row_mask:0xf bank_mask:0x2
  v_mov_b32_dpp v246, v13 row_ror:4 row_mask:0xf bank_mask:0x4
  v_mov_b32_dpp v247, v13 row_ror:8 row_mask:0xf bank_mask:0x8
  v_mov_b32_dpp v248, v13 row_ror:8 row_mask:0xf bank_mask:0x1
  v_mov_b32_dpp v249, v13 row_ror:12 row_mask:0xf bank_mask:0x2
  v_mov_b32_dpp v250, v13 quad_perm:[0,1,2,3] row_mask:0xf bank_mask:0x4
  v_mov_b32_dpp v251, v13 row_ror:4 row_mask:0xf bank_mask:0x8
  v_mov_b32_dpp v252, v13 row_ror:4 row_mask:0xf bank_mask:0x1
  v_mov_b32_dpp v253, v13 row_ror:8 row_mask:0xf bank_mask:0x2
  v_mov_b32_dpp v254, v13 row_ror:12 row_mask:0xf bank_mask:0x4
  v_mov_b32_dpp v255, v13 quad_perm:[0,1,2,3] row_mask:0xf bank_mask:0x8
  s_nop 1
  v_mfma_f32_16x16x32_bf16 v[16:19], v[96:99], v[20:23], v[16:19]
  v_mfma_f32_16x16x32_bf16 v[16:19], v[100:103], v[24:27], v[16:19]
  v_mfma_f32_16x16x32_bf16 v[16:19], v[104:107], v[28:31], v[16:19]
  v_mfma_f32_16x16x32_bf16 v[16:19], v[108:111], v[32:35], v[16:19]
  v_mfma_f32_16x16x32_bf16 v[16:19], v[112:115], v[240:243], v[16:19]
  v_mfma_f32_16x16x32_bf16 v[16:19], v[116:119], v[244:247], v[16:19]
  v_mfma_f32_16x16x32_bf16 v[16:19], v[120:123], v[248:251], v[16:19]
  v_mfma_f32_16x16x32_bf16 v[16:19], v[124:127], v[252:255], v[16:19]
  s_branch L_v2
L_tr2:
  s_nop 1
  v_max_f32_dpp v6, v6, v6 quad_perm:[1,0,3,2] row_mask:0xf bank_mask:0xf
  s_nop 1
  v_max_f32_dpp v6, v6, v6 quad_perm:[2,3,0,1] row_mask:0xf bank_mask:0xf
  s_nop 1
  v_max_f32_dpp v6, v6, v6 row_half_mirror row_mask:0xf bank_mask:0xf
  s_nop 1
  v_max_f32_dpp v6, v6, v6 row_mirror row_mask:0xf bank_mask:0xf
  s_nop 1
  v_max_f32_dpp v6, v6, v6 row_bcast:15 row_mask:0xa bank_mask:0xf
  s_nop 1
  v_max_f32_dpp v6, v6, v6 row_bcast:31 row_mask:0xc bank_mask:0xf
  s_mov_b32 exec_lo, 0
  s_mov_b32 exec_hi, 0x80000000
  ds_write_b32 v57, v6 offset:64
  ds_add_u32 v36, v41 offset:24
  s_mov_b64 exec, -1
  v_subrev_u32 v39, 8192, v39
  s_cmp_ge_u32 s86, s67
  s_cbranch_scc1 L_x2
  s_cmp_eq_u32 s65, 1
  s_cbranch_scc1 L_d1t2
  s_waitcnt vmcnt(8)
  s_branch L_d2t2
L_d1t2:
  s_waitcnt vmcnt(0)
  s_mov_b64 exec, 1
  ds_add_rtn_u32 v42, v40, v41 offset:0
  ds_read_b32 v58, v40 offset:4
  s_mov_b64 exec, -1
  s_waitcnt lgkmcnt(0)
  v_readfirstlane_b32 s84, v42
  v_readfirstlane_b32 s64, v58
  s_cmp_lt_u32 s84, 128
  s_cselect_b64 s[52:53], s[44:45], s[48:49]
  s_cselect_b64 s[54:55], s[46:47], s[50:51]
  s_bitcmp1_b32 s84, 6
  s_cselect_b64 s[40:41], s[54:55], s[52:53]
  s_lshr_b32 s75, s84, 1
  s_mul_i32 s75, s75, 49152
  s_lshl_b32 s79, s84, 13
  s_add_u32 s79, s79, s75
  buffer_load_dwordx4 v[64:67], v1, s[40:43], s79 offen offset:0 nt
  buffer_load_dwordx4 v[68:71], v1, s[40:43], s79 offen offset:1024 nt
  buffer_load_dwordx4 v[72:75], v1, s[40:43], s79 offen offset:2048 nt
  buffer_load_dwordx4 v[76:79], v1, s[40:43], s79 offen offset:3072 nt
  buffer_load_dwordx4 v[80:83], v47, s[40:43], s79 offen offset:0 nt
  buffer_load_dwordx4 v[84:87], v47, s[40:43], s79 offen offset:1024 nt
  buffer_load_dwordx4 v[88:91], v47, s[40:43], s79 offen offset:2048 nt
  buffer_load_dwordx4 v[92:95], v47, s[40:43], s79 offen offset:3072 nt
L_d2t2:
  s_mov_b32 s65, 1
  s_cmp_le_u32 s64, s3
  s_cbranch_scc1 L_d3t2
  s_mov_b64 exec, 1
  ds_add_rtn_u32 v42, v40, v41 offset:0
  ds_read_b32 v58, v40 offset:4
  s_mov_b64 exec, -1
  s_waitcnt lgkmcnt(0)
  v_readfirstlane_b32 s85, v42
  v_readfirstlane_b32 s64, v58
  s_cmp_lt_u32 s85, 128
  s_cselect_b64 s[52:53], s[44:45], s[48:49]
  s_cselect_b64 s[54:55], s[46:47], s[50:51]
  s_bitcmp1_b32 s85, 6
  s_cselect_b64 s[40:41], s[54:55], s[52:53]
  s_lshr_b32 s75, s85, 1
  s_mul_i32 s75, s75, 49152
  s_lshl_b32 s79, s85, 13
  s_add_u32 s79, s79, s75
  buffer_load_dwordx4 v[96:99], v1, s[40:43], s79 offen offset:0 nt
  buffer_load_dwordx4 v[100:103], v1, s[40:43], s79 offen offset:1024 nt
  buffer_load_dwordx4 v[104:107], v1, s[40:43], s79 offen offset:2048 nt
  buffer_load_dwordx4 v[108:111], v1, s[40:43], s79 offen offset:3072 nt
  buffer_load_dwordx4 v[112:115], v47, s[40:43], s79 offen offset:0 nt
  buffer_load_dwordx4 v[116:119], v47, s[40:43], s79 offen offset:1024 nt
  buffer_load_dwordx4 v[120:123], v47, s[40:43], s79 offen offset:2048 nt
  buffer_load_dwordx4 v[124:127], v47, s[40:43], s79 offen offset:3072 nt
  s_mov_b32 s65, 2
L_d3t2:
L_tw2:
  ds_read_b32 v58, v36 offset:24
  ds_read_b128 v[48:51], v44 offset:64
  s_waitcnt lgkmcnt(0)
  v_readfirstlane_b32 s75, v58
  s_cmp_lt_u32 s75, 3
  s_cbranch_scc1 L_tw2
  v_max3_f32 v48, v48, v49, v50
  v_mul_f32 v5, v48, v4
  v_sub_f32 v5, 0, v5
  s_lshl_b32 s75, s86, 7
  v_add_u32 v43, s75, v39
  ds_read_b32 v12, v43 offset:25600
  ds_read_b32 v13, v43 offset:25664
  s_waitcnt lgkmcnt(0)
  v_fma_f32 v12, v12, v4, v5
  v_fma_f32 v13, v13, v4, v5
  v_exp_f32 v12, v12
  v_exp_f32 v13, v13
  s_nop 0
  v_and_b32 v14, v12, v2
  v_and_b32 v15, v13, v2
  v_sub_f32 v12, v12, v14
  v_sub_f32 v13, v13, v15
  v_perm_b32 v12, v12, v12, v3
  v_perm_b32 v13, v13, v13, v3
  s_nop 1
  v_mov_b32_dpp v20, v12 quad_perm:[0,1,2,3] row_mask:0xf bank_mask:0x1
  v_mov_b32_dpp v21, v12 row_ror:4 row_mask:0xf bank_mask:0x2
  v_mov_b32_dpp v22, v12 row_ror:8 row_mask:0xf bank_mask:0x4
  v_mov_b32_dpp v23, v12 row_ror:12 row_mask:0xf bank_mask:0x8
  v_mov_b32_dpp v24, v12 row_ror:12 row_mask:0xf bank_mask:0x1
  v_mov_b32_dpp v25, v12 quad_perm:[0,1,2,3] row_mask:0xf bank_mask:0x2
  v_mov_b32_dpp v26, v12 row_ror:4 row_mask:0xf bank_mask:0x4
  v_mov_b32_dpp v27, v12 row_ror:8 row_mask:0xf bank_mask:0x8
  v_mov_b32_dpp v28, v12 row_ror:8 row_mask:0xf bank_mask:0x1
  v_mov_b32_dpp v29, v12 row_ror:12 row_mask:0xf bank_mask:0x2
  v_mov_b32_dpp v30, v12 quad_perm:[0,1,2,3] row_mask:0xf bank_mask:0x4
  v_mov_b32_dpp v31, v12 row_ror:4 row_mask:0xf bank_mask:0x8
  v_mov_b32_dpp v32, v12 row_ror:4 row_mask:0xf bank_mask:0x1
  v_mov_b32_dpp v33, v12 row_ror:8 row_mask:0xf bank_mask:0x2
  v_mov_b32_dpp v34, v12 row_ror:12 row_mask:0xf bank_mask:0x4
  v_mov_b32_dpp v35, v12 quad_perm:[0,1,2,3] row_mask:0xf bank_mask:0x8
  v_mov_b32_dpp v240, v13 quad_perm:[0,1,2,3] row_mask:0xf bank_mask:0x1
  v_mov_b32_dpp v241, v13 row_ror:4 row_mask:0xf bank_mask:0x2
  v_mov_b32_dpp v242, v13 row_ror:8 row_mask:0xf bank_mask:0x4
  v_mov_b32_dpp v243, v13 row_ror:12 row_mask:0xf bank_mask:0x8
  v_mov_b32_dpp v244, v13 row_ror:12 row_mask:0xf bank_mask:0x1
  v_mov_b32_dpp v245, v13 quad_perm:[0,1,2,3] row_mask:0xf bank_mask:0x2
  v_mov_b32_dpp v246, v13 row_ror:4 row_mask:0xf bank_mask:0x4
  v_mov_b32_dpp v247, v13 row_ror:8 row_mask:0xf bank_mask:0x8
  v_mov_b32_dpp v248, v13 row_ror:8 row_mask:0xf bank_mask:0x1
  v_mov_b32_dpp v249, v13 row_ror:12 row_mask:0xf bank_mask:0x2
  v_mov_b32_dpp v250, v13 quad_perm:[0,1,2,3] row_mask:0xf bank_mask:0x4
  v_mov_b32_dpp v251, v13 row_ror:4 row_mask:0xf bank_mask:0x8
  v_mov_b32_dpp v252, v13 row_ror:4 row_mask:0xf bank_mask:0x1
  v_mov_b32_dpp v253, v13 row_ror:8 row_mask:0xf bank_mask:0x2
  v_mov_b32_dpp v254, v13 row_ror:12 row_mask:0xf bank_mask:0x4
  v_mov_b32_dpp v255, v13 quad_perm:[0,1,2,3] row_mask:0xf bank_mask:0x8
  s_nop 1
  v_mfma_f32_16x16x32_bf16 v[16:19], v[128:131], v[20:23], v[16:19]
  v_mfma_f32_16x16x32_bf16 v[16:19], v[132:135], v[24:27], v[16:19]
  v_mfma_f32_16x16x32_bf16 v[16:19], v[136:139], v[28:31], v[16:19]
  v_mfma_f32_16x16x32_bf16 v[16:19], v[140:143], v[32:35], v[16:19]
  v_mfma_f32_16x16x32_bf16 v[16:19], v[144:147], v[240:243], v[16:19]
  v_mfma_f32_16x16x32_bf16 v[16:19], v[148:151], v[244:247], v[16:19]
  v_mfma_f32_16x16x32_bf16 v[16:19], v[152:155], v[248:251], v[16:19]
  v_mfma_f32_16x16x32_bf16 v[16:19], v[156:159], v[252:255], v[16:19]
  s_branch L_v0
  .p2align 5
L_v0:
  s_cmp_ge_u32 s84, s67
  s_cbranch_scc1 L_x0
  s_lshl_b32 s75, s84, 7
  v_add_u32 v43, s75, v39
  ds_read_b32 v12, v43 offset:25600
  ds_read_b32 v13, v43 offset:25664
  s_waitcnt lgkmcnt(0)
  v_fma_f32 v12, v12, v4, v5
  v_fma_f32 v13, v13, v4, v5
  v_exp_f32 v12, v12
  v_exp_f32 v13, v13
  s_nop 0
  v_and_b32 v14, v12, v2
  v_and_b32 v15, v13, v2
  v_sub_f32 v12, v12, v14
  v_sub_f32 v13, v13, v15
  v_perm_b32 v12, v12, v12, v3
  v_perm_b32 v13, v13, v13, v3
  s_nop 1
  v_mov_b32_dpp v20, v12 quad_perm:[0,1,2,3] row_mask:0xf bank_mask:0x1
  v_mov_b32_dpp v21, v12 row_ror:4 row_mask:0xf bank_mask:0x2
  v_mov_b32_dpp v22, v12 row_ror:8 row_mask:0xf bank_mask:0x4
  v_mov_b32_dpp v23, v12 row_ror:12 row_mask:0xf bank_mask:0x8
  v_mov_b32_dpp v24, v12 row_ror:12 row_mask:0xf bank_mask:0x1
  v_mov_b32_dpp v25, v12 quad_perm:[0,1,2,3] row_mask:0xf bank_mask:0x2
  v_mov_b32_dpp v26, v12 row_ror:4 row_mask:0xf bank_mask:0x4
  v_mov_b32_dpp v27, v12 row_ror:8 row_mask:0xf bank_mask:0x8
  v_mov_b32_dpp v28, v12 row_ror:8 row_mask:0xf bank_mask:0x1
  v_mov_b32_dpp v29, v12 row_ror:12 row_mask:0xf bank_mask:0x2
  v_mov_b32_dpp v30, v12 quad_perm:[0,1,2,3] row_mask:0xf bank_mask:0x4
  v_mov_b32_dpp v31, v12 row_ror:4 row_mask:0xf bank_mask:0x8
  v_mov_b32_dpp v32, v12 row_ror:4 row_mask:0xf bank_mask:0x1
  v_mov_b32_dpp v33, v12 row_ror:8 row_mask:0xf bank_mask:0x2
  v_mov_b32_dpp v34, v12 row_ror:12 row_mask:0xf bank_mask:0x4
  v_mov_b32_dpp v35, v12 quad_perm:[0,1,2,3] row_mask:0xf bank_mask:0x8
  v_mov_b32_dpp v240, v13 quad_perm:[0,1,2,3] row_mask:0xf bank_mask:0x1
  v_mov_b32_dpp v241, v13 row_ror:4 row_mask:0xf bank_mask:0x2
  v_mov_b32_dpp v242, v13 row_ror:8 row_mask:0xf bank_mask:0x4
  v_mov_b32_dpp v243, v13 row_ror:12 row_mask:0xf bank_mask:0x8
  v_mov_b32_dpp v244, v13 row_ror:12 row_mask:0xf bank_mask:0x1
  v_mov_b32_dpp v245, v13 quad_perm:[0,1,2,3] row_mask:0xf bank_mask:0x2
  v_mov_b32_dpp v246, v13 row_ror:4 row_mask:0xf bank_mask:0x4
  v_mov_b32_dpp v247, v13 row_ror:8 row_mask:0xf bank_mask:0x8
  v_mov_b32_dpp v248, v13 row_ror:8 row_mask:0xf bank_mask:0x1
  v_mov_b32_dpp v249, v13 row_ror:12 row_mask:0xf bank_mask:0x2
  v_mov_b32_dpp v250, v13 quad_perm:[0,1,2,3] row_mask:0xf bank_mask:0x4
  v_mov_b32_dpp v251, v13 row_ror:4 row_mask:0xf bank_mask:0x8
  v_mov_b32_dpp v252, v13 row_ror:4 row_mask:0xf bank_mask:0x1
  v_mov_b32_dpp v253, v13 row_ror:8 row_mask:0xf bank_mask:0x2
  v_mov_b32_dpp v254, v13 row_ror:12 row_mask:0xf bank_mask:0x4
  v_mov_b32_dpp v255, v13 quad_perm:[0,1,2,3] row_mask:0xf bank_mask:0x8
  s_cmp_eq_u32 s65, 1
  s_cbranch_scc1 L_d1v0
  s_waitcnt vmcnt(8)
  v_mfma_f32_16x16x32_bf16 v[16:19], v[64:67], v[20:23], v[16:19]
  v_mfma_f32_16x16x32_bf16 v[16:19], v[68:71], v[24:27], v[16:19]
  v_mfma_f32_16x16x32_bf16 v[16:19], v[72:75], v[28:31], v[16:19]
  v_mfma_f32_16x16x32_bf16 v[16:19], v[76:79], v[32:35], v[16:19]
  v_mfma_f32_16x16x32_bf16 v[16:19], v[80:83], v[240:243], v[16:19]
  v_mfma_f32_16x16x32_bf16 v[16:19], v[84:87], v[244:247], v[16:19]
  v_mfma_f32_16x16x32_bf16 v[16:19], v[88:91], v[248:251], v[16:19]
  v_mfma_f32_16x16x32_bf16 v[16:19], v[92:95], v[252:255], v[16:19]
  s_branch L_d2v0
L_d1v0:
  s_waitcnt vmcnt(0)
  v_mfma_f32_16x16x32_bf16 v[16:19], v[64:67], v[20:23], v[16:19]
  v_mfma_f32_16x16x32_bf16 v[16:19], v[68:71], v[24:27], v[16:19]
  v_mfma_f32_16x16x32_bf16 v[16:19], v[72:75], v[28:31], v[16:19]
  v_mfma_f32_16x16x32_bf16 v[16:19], v[76:79], v[32:35], v[16:19]
  v_mfma_f32_16x16x32_bf16 v[16:19], v[80:83], v[240:243], v[16:19]
  v_mfma_f32_16x16x32_bf16 v[16:19], v[84:87], v[244:247], v[16:19]
  v_mfma_f32_16x16x32_bf16 v[16:19], v[88:91], v[248:251], v[16:19]
  v_mfma_f32_16x16x32_bf16 v[16:19], v[92:95], v[252:255], v[16:19]
  s_mov_b64 exec, 1
  ds_add_rtn_u32 v42, v40, v41 offset:0
  ds_read_b32 v58, v40 offset:4
  s_mov_b64 exec, -1
  s_waitcnt lgkmcnt(0)
  v_readfirstlane_b32 s85, v42
  v_readfirstlane_b32 s64, v58
  s_cmp_lt_u32 s85, 128
  s_cselect_b64 s[52:53], s[44:45], s[48:49]
  s_cselect_b64 s[54:55], s[46:47], s[50:51]
  s_bitcmp1_b32 s85, 6
  s_cselect_b64 s[40:41], s[54:55], s[52:53]
  s_lshr_b32 s75, s85, 1
  s_mul_i32 s75, s75, 49152
  s_lshl_b32 s79, s85, 13
  s_add_u32 s79, s79, s75
  s_cmp_ge_u32 s85, 256
  s_cbranch_scc1 L_x1
  buffer_load_dwordx4 v[96:99], v1, s[40:43], s79 offen offset:0 nt
  buffer_load_dwordx4 v[100:103], v1, s[40:43], s79 offen offset:1024 nt
  buffer_load_dwordx4 v[104:107], v1, s[40:43], s79 offen offset:2048 nt
  buffer_load_dwordx4 v[108:111], v1, s[40:43], s79 offen offset:3072 nt
  buffer_load_dwordx4 v[112:115], v47, s[40:43], s79 offen offset:0 nt
  buffer_load_dwordx4 v[116:119], v47, s[40:43], s79 offen offset:1024 nt
  buffer_load_dwordx4 v[120:123], v47, s[40:43], s79 offen offset:2048 nt
  buffer_load_dwordx4 v[124:127], v47, s[40:43], s79 offen offset:3072 nt
L_d2v0:
  s_mov_b32 s65, 1
  s_cmp_le_u32 s64, s3
  s_cbranch_scc1 L_d3v0
  s_mov_b64 exec, 1
  ds_add_rtn_u32 v42, v40, v41 offset:0
  ds_read_b32 v58, v40 offset:4
  s_mov_b64 exec, -1
  s_waitcnt lgkmcnt(0)
  v_readfirstlane_b32 s86, v42
  v_readfirstlane_b32 s64, v58
  s_cmp_lt_u32 s86, 128
  s_cselect_b64 s[52:53], s[44:45], s[48:49]
  s_cselect_b64 s[54:55], s[46:47], s[50:51]
  s_bitcmp1_b32 s86, 6
  s_cselect_b64 s[40:41], s[54:55], s[52:53]
  s_lshr_b32 s75, s86, 1
  s_mul_i32 s75, s75, 49152
  s_lshl_b32 s79, s86, 13
  s_add_u32 s79, s79, s75
  buffer_load_dwordx4 v[128:131], v1, s[40:43], s79 offen offset:0 nt
  buffer_load_dwordx4 v[132:135], v1, s[40:43], s79 offen offset:1024 nt
  buffer_load_dwordx4 v[136:139], v1, s[40:43], s79 offen offset:2048 nt
  buffer_load_dwordx4 v[140:143], v1, s[40:43], s79 offen offset:3072 nt
  buffer_load_dwordx4 v[144:147], v47, s[40:43], s79 offen offset:0 nt
  buffer_load_dwordx4 v[148:151], v47, s[40:43], s79 offen offset:1024 nt
  buffer_load_dwordx4 v[152:155], v47, s[40:43], s79 offen offset:2048 nt
  buffer_load_dwordx4 v[156:159], v47, s[40:43], s79 offen offset:3072 nt
  s_mov_b32 s65, 2
L_d3v0:
L_v1:
  s_cmp_ge_u32 s85, s67
  s_cbranch_scc1 L_x1
  s_lshl_b32 s75, s85, 7
  v_add_u32 v43, s75, v39
  ds_read_b32 v12, v43 offset:25600
  ds_read_b32 v13, v43 offset:25664
  s_waitcnt lgkmcnt(0)
  v_fma_f32 v12, v12, v4, v5
  v_fma_f32 v13, v13, v4, v5
  v_exp_f32 v12, v12
  v_exp_f32 v13, v13
  s_nop 0
  v_and_b32 v14, v12, v2
  v_and_b32 v15, v13, v2
  v_sub_f32 v12, v12, v14
  v_sub_f32 v13, v13, v15
  v_perm_b32 v12, v12, v12, v3
  v_perm_b32 v13, v13, v13, v3
  s_nop 1
  v_mov_b32_dpp v20, v12 quad_perm:[0,1,2,3] row_mask:0xf bank_mask:0x1
  v_mov_b32_dpp v21, v12 row_ror:4 row_mask:0xf bank_mask:0x2
  v_mov_b32_dpp v22, v12 row_ror:8 row_mask:0xf bank_mask:0x4
  v_mov_b32_dpp v23, v12 row_ror:12 row_mask:0xf bank_mask:0x8
  v_mov_b32_dpp v24, v12 row_ror:12 row_mask:0xf bank_mask:0x1
  v_mov_b32_dpp v25, v12 quad_perm:[0,1,2,3] row_mask:0xf bank_mask:0x2
  v_mov_b32_dpp v26, v12 row_ror:4 row_mask:0xf bank_mask:0x4
  v_mov_b32_dpp v27, v12 row_ror:8 row_mask:0xf bank_mask:0x8
  v_mov_b32_dpp v28, v12 row_ror:8 row_mask:0xf bank_mask:0x1
  v_mov_b32_dpp v29, v12 row_ror:12 row_mask:0xf bank_mask:0x2
  v_mov_b32_dpp v30, v12 quad_perm:[0,1,2,3] row_mask:0xf bank_mask:0x4
  v_mov_b32_dpp v31, v12 row_ror:4 row_mask:0xf bank_mask:0x8
  v_mov_b32_dpp v32, v12 row_ror:4 row_mask:0xf bank_mask:0x1
  v_mov_b32_dpp v33, v12 row_ror:8 row_mask:0xf bank_mask:0x2
  v_mov_b32_dpp v34, v12 row_ror:12 row_mask:0xf bank_mask:0x4
  v_mov_b32_dpp v35, v12 quad_perm:[0,1,2,3] row_mask:0xf bank_mask:0x8
  v_mov_b32_dpp v240, v13 quad_perm:[0,1,2,3] row_mask:0xf bank_mask:0x1
  v_mov_b32_dpp v241, v13 row_ror:4 row_mask:0xf bank_mask:0x2
  v_mov_b32_dpp v242, v13 row_ror:8 row_mask:0xf bank_mask:0x4
  v_mov_b32_dpp v243, v13 row_ror:12 row_mask:0xf bank_mask:0x8
  v_mov_b32_dpp v244, v13 row_ror:12 row_mask:0xf bank_mask:0x1
  v_mov_b32_dpp v245, v13 quad_perm:[0,1,2,3] row_mask:0xf bank_mask:0x2
  v_mov_b32_dpp v246, v13 row_ror:4 row_mask:0xf bank_mask:0x4
  v_mov_b32_dpp v247, v13 row_ror:8 row_mask:0xf bank_mask:0x8
  v_mov_b32_dpp v248, v13 row_ror:8 row_mask:0xf bank_mask:0x1
  v_mov_b32_dpp v249, v13 row_ror:12 row_mask:0xf bank_mask:0x2
  v_mov_b32_dpp v250, v13 quad_perm:[0,1,2,3] row_mask:0xf bank_mask:0x4
  v_mov_b32_dpp v251, v13 row_ror:4 row_mask:0xf bank_mask:0x8
  v_mov_b32_dpp v252, v13 row_ror:4 row_mask:0xf bank_mask:0x1
  v_mov_b32_dpp v253, v13 row_ror:8 row_mask:0xf bank_mask:0x2
  v_mov_b32_dpp v254, v13 row_ror:12 row_mask:0xf bank_mask:0x4
  v_mov_b32_dpp v255, v13 quad_perm:[0,1,2,3] row_mask:0xf bank_mask:0x8
  s_cmp_eq_u32 s65, 1
  s_cbranch_scc1 L_d1v1
  s_waitcnt vmcnt(8)
  v_mfma_f32_16x16x32_bf16 v[16:19], v[96:99], v[20:23], v[16:19]
  v_mfma_f32_16x16x32_bf16 v[16:19], v[100:103], v[24:27], v[16:19]
  v_mfma_f32_16x16x32_bf16 v[16:19], v[104:107], v[28:31], v[16:19]
  v_mfma_f32_16x16x32_bf16 v[16:19], v[108:111], v[32:35], v[16:19]
  v_mfma_f32_16x16x32_bf16 v[16:19], v[112:115], v[240:243], v[16:19]
  v_mfma_f32_16x16x32_bf16 v[16:19], v[116:119], v[244:247], v[16:19]
  v_mfma_f32_16x16x32_bf16 v[16:19], v[120:123], v[248:251], v[16:19]
  v_mfma_f32_16x16x32_bf16 v[16:19], v[124:127], v[252:255], v[16:19]
  s_branch L_d2v1
L_d1v1:
  s_waitcnt vmcnt(0)
  v_mfma_f32_16x16x32_bf16 v[16:19], v[96:99], v[20:23], v[16:19]
  v_mfma_f32_16x16x32_bf16 v[16:19], v[100:103], v[24:27], v[16:19]
  v_mfma_f32_16x16x32_bf16 v[16:19], v[104:107], v[28:31], v[16:19]
  v_mfma_f32_16x16x32_bf16 v[16:19], v[108:111], v[32:35], v[16:19]
  v_mfma_f32_16x16x32_bf16 v[16:19], v[112:115], v[240:243], v[16:19]
  v_mfma_f32_16x16x32_bf16 v[16:19], v[116:119], v[244:247], v[16:19]
  v_mfma_f32_16x16x32_bf16 v[16:19], v[120:123], v[248:251], v[16:19]
  v_mfma_f32_16x16x32_bf16 v[16:19], v[124:127], v[252:255], v[16:19]
  s_mov_b64 exec, 1
  ds_add_rtn_u32 v42, v40, v41 offset:0
  ds_read_b32 v58, v40 offset:4
  s_mov_b64 exec, -1
  s_waitcnt lgkmcnt(0)
  v_readfirstlane_b32 s86, v42
  v_readfirstlane_b32 s64, v58
  s_cmp_lt_u32 s86, 128
  s_cselect_b64 s[52:53], s[44:45], s[48:49]
  s_cselect_b64 s[54:55], s[46:47], s[50:51]
  s_bitcmp1_b32 s86, 6
  s_cselect_b64 s[40:41], s[54:55], s[52:53]
  s_lshr_b32 s75, s86, 1
  s_mul_i32 s75, s75, 49152
  s_lshl_b32 s79, s86, 13
  s_add_u32 s79, s79, s75
  s_cmp_ge_u32 s86, 256
  s_cbranch_scc1 L_x2
  buffer_load_dwordx4 v[128:131], v1, s[40:43], s79 offen offset:0 nt
  buffer_load_dwordx4 v[132:135], v1, s[40:43], s79 offen offset:1024 nt
  buffer_load_dwordx4 v[136:139], v1, s[40:43], s79 offen offset:2048 nt
  buffer_load_dwordx4 v[140:143], v1, s[40:43], s79 offen offset:3072 nt
  buffer_load_dwordx4 v[144:147], v47, s[40:43], s79 offen offset:0 nt
  buffer_load_dwordx4 v[148:151], v47, s[40:43], s79 offen offset:1024 nt
  buffer_load_dwordx4 v[152:155], v47, s[40:43], s79 offen offset:2048 nt
  buffer_load_dwordx4 v[156:159], v47, s[40:43], s79 offen offset:3072 nt
L_d2v1:
  s_mov_b32 s65, 1
  s_cmp_le_u32 s64, s3
  s_cbranch_scc1 L_d3v1
  s_mov_b64 exec, 1
  ds_add_rtn_u32 v42, v40, v41 offset:0
  ds_read_b32 v58, v40 offset:4
  s_mov_b64 exec, -1
  s_waitcnt lgkmcnt(0)
  v_readfirstlane_b32 s84, v42
  v_readfirstlane_b32 s64, v58
  s_cmp_lt_u32 s84, 128
  s_cselect_b64 s[52:53], s[44:45], s[48:49]
  s_cselect_b64 s[54:55], s[46:47], s[50:51]
  s_bitcmp1_b32 s84, 6
  s_cselect_b64 s[40:41], s[54:55], s[52:53]
  s_lshr_b32 s75, s84, 1
  s_mul_i32 s75, s75, 49152
  s_lshl_b32 s79, s84, 13
  s_add_u32 s79, s79, s75
  buffer_load_dwordx4 v[64:67], v1, s[40:43], s79 offen offset:0 nt
  buffer_load_dwordx4 v[68:71], v1, s[40:43], s79 offen offset:1024 nt
  buffer_load_dwordx4 v[72:75], v1, s[40:43], s79 offen offset:2048 nt
  buffer_load_dwordx4 v[76:79], v1, s[40:43], s79 offen offset:3072 nt
  buffer_load_dwordx4 v[80:83], v47, s[40:43], s79 offen offset:0 nt
  buffer_load_dwordx4 v[84:87], v47, s[40:43], s79 offen offset:1024 nt
  buffer_load_dwordx4 v[88:91], v47, s[40:43], s79 offen offset:2048 nt
  buffer_load_dwordx4 v[92:95], v47, s[40:43], s79 offen offset:3072 nt
  s_mov_b32 s65, 2
L_d3v1:
L_v2:
  s_cmp_ge_u32 s86, s67
  s_cbranch_scc1 L_x2
  s_lshl_b32 s75, s86, 7
  v_add_u32 v43, s75, v39
  ds_read_b32 v12, v43 offset:25600
  ds_read_b32 v13, v43 offset:25664
  s_waitcnt lgkmcnt(0)
  v_fma_f32 v12, v12, v4, v5
  v_fma_f32 v13, v13, v4, v5
  v_exp_f32 v12, v12
  v_exp_f32 v13, v13
  s_nop 0
  v_and_b32 v14, v12, v2
  v_and_b32 v15, v13, v2
  v_sub_f32 v12, v12, v14
  v_sub_f32 v13, v13, v15
  v_perm_b32 v12, v12, v12, v3
  v_perm_b32 v13, v13, v13, v3
  s_nop 1
  v_mov_b32_dpp v20, v12 quad_perm:[0,1,2,3] row_mask:0xf bank_mask:0x1
  v_mov_b32_dpp v21, v12 row_ror:4 row_mask:0xf bank_mask:0x2
  v_mov_b32_dpp v22, v12 row_ror:8 row_mask:0xf bank_mask:0x4
  v_mov_b32_dpp v23, v12 row_ror:12 row_mask:0xf bank_mask:0x8
  v_mov_b32_dpp v24, v12 row_ror:12 row_mask:0xf bank_mask:0x1
  v_mov_b32_dpp v25, v12 quad_perm:[0,1,2,3] row_mask:0xf bank_mask:0x2
  v_mov_b32_dpp v26, v12 row_ror:4 row_mask:0xf bank_mask:0x4
  v_mov_b32_dpp v27, v12 row_ror:8 row_mask:0xf bank_mask:0x8
  v_mov_b32_dpp v28, v12 row_ror:8 row_mask:0xf bank_mask:0x1
  v_mov_b32_dpp v29, v12 row_ror:12 row_mask:0xf bank_mask:0x2
  v_mov_b32_dpp v30, v12 quad_perm:[0,1,2,3] row_mask:0xf bank_mask:0x4
  v_mov_b32_dpp v31, v12 row_ror:4 row_mask:0xf bank_mask:0x8
  v_mov_b32_dpp v32, v12 row_ror:4 row_mask:0xf bank_mask:0x1
  v_mov_b32_dpp v33, v12 row_ror:8 row_mask:0xf bank_mask:0x2
  v_mov_b32_dpp v34, v12 row_ror:12 row_mask:0xf bank_mask:0x4
  v_mov_b32_dpp v35, v12 quad_perm:[0,1,2,3] row_mask:0xf bank_mask:0x8
  v_mov_b32_dpp v240, v13 quad_perm:[0,1,2,3] row_mask:0xf bank_mask:0x1
  v_mov_b32_dpp v241, v13 row_ror:4 row_mask:0xf bank_mask:0x2
  v_mov_b32_dpp v242, v13 row_ror:8 row_mask:0xf bank_mask:0x4
  v_mov_b32_dpp v243, v13 row_ror:12 row_mask:0xf bank_mask:0x8
  v_mov_b32_dpp v244, v13 row_ror:12 row_mask:0xf bank_mask:0x1
  v_mov_b32_dpp v245, v13 quad_perm:[0,1,2,3] row_mask:0xf bank_mask:0x2
  v_mov_b32_dpp v246, v13 row_ror:4 row_mask:0xf bank_mask:0x4
  v_mov_b32_dpp v247, v13 row_ror:8 row_mask:0xf bank_mask:0x8
  v_mov_b32_dpp v248, v13 row_ror:8 row_mask:0xf bank_mask:0x1
  v_mov_b32_dpp v249, v13 row_ror:12 row_mask:0xf bank_mask:0x2
  v_mov_b32_dpp v250, v13 quad_perm:[0,1,2,3] row_mask:0xf bank_mask:0x4
  v_mov_b32_dpp v251, v13 row_ror:4 row_mask:0xf bank_mask:0x8
  v_mov_b32_dpp v252, v13 row_ror:4 row_mask:0xf bank_mask:0x1
  v_mov_b32_dpp v253, v13 row_ror:8 row_mask:0xf bank_mask:0x2
  v_mov_b32_dpp v254, v13 row_ror:12 row_mask:0xf bank_mask:0x4
  v_mov_b32_dpp v255, v13 quad_perm:[0,1,2,3] row_mask:0xf bank_mask:0x8
  s_cmp_eq_u32 s65, 1
  s_cbranch_scc1 L_d1v2
  s_waitcnt vmcnt(8)
  v_mfma_f32_16x16x32_bf16 v[16:19], v[128:131], v[20:23], v[16:19]
  v_mfma_f32_16x16x32_bf16 v[16:19], v[132:135], v[24:27], v[16:19]
  v_mfma_f32_16x16x32_bf16 v[16:19], v[136:139], v[28:31], v[16:19]
  v_mfma_f32_16x16x32_bf16 v[16:19], v[140:143], v[32:35], v[16:19]
  v_mfma_f32_16x16x32_bf16 v[16:19], v[144:147], v[240:243], v[16:19]
  v_mfma_f32_16x16x32_bf16 v[16:19], v[148:151], v[244:247], v[16:19]
  v_mfma_f32_16x16x32_bf16 v[16:19], v[152:155], v[248:251], v[16:19]
  v_mfma_f32_16x16x32_bf16 v[16:19], v[156:159], v[252:255], v[16:19]
  s_branch L_d2v2
L_d1v2:
  s_waitcnt vmcnt(0)
  v_mfma_f32_16x16x32_bf16 v[16:19], v[128:131], v[20:23], v[16:19]
  v_mfma_f32_16x16x32_bf16 v[16:19], v[132:135], v[24:27], v[16:19]
  v_mfma_f32_16x16x32_bf16 v[16:19], v[136:139], v[28:31], v[16:19]
  v_mfma_f32_16x16x32_bf16 v[16:19], v[140:143], v[32:35], v[16:19]
  v_mfma_f32_16x16x32_bf16 v[16:19], v[144:147], v[240:243], v[16:19]
  v_mfma_f32_16x16x32_bf16 v[16:19], v[148:151], v[244:247], v[16:19]
  v_mfma_f32_16x16x32_bf16 v[16:19], v[152:155], v[248:251], v[16:19]
  v_mfma_f32_16x16x32_bf16 v[16:19], v[156:159], v[252:255], v[16:19]
  s_mov_b64 exec, 1
  ds_add_rtn_u32 v42, v40, v41 offset:0
  ds_read_b32 v58, v40 offset:4
  s_mov_b64 exec, -1
  s_waitcnt lgkmcnt(0)
  v_readfirstlane_b32 s84, v42
  v_readfirstlane_b32 s64, v58
  s_cmp_lt_u32 s84, 128
  s_cselect_b64 s[52:53], s[44:45], s[48:49]
  s_cselect_b64 s[54:55], s[46:47], s[50:51]
  s_bitcmp1_b32 s84, 6
  s_cselect_b64 s[40:41], s[54:55], s[52:53]
  s_lshr_b32 s75, s84, 1
  s_mul_i32 s75, s75, 49152
  s_lshl_b32 s79, s84, 13
  s_add_u32 s79, s79, s75
  s_cmp_ge_u32 s84, 256
  s_cbranch_scc1 L_x0
  buffer_load_dwordx4 v[64:67], v1, s[40:43], s79 offen offset:0 nt
  buffer_load_dwordx4 v[68:71], v1, s[40:43], s79 offen offset:1024 nt
  buffer_load_dwordx4 v[72:75], v1, s[40:43], s79 offen offset:2048 nt
  buffer_load_dwordx4 v[76:79], v1, s[40:43], s79 offen offset:3072 nt
  buffer_load_dwordx4 v[80:83], v47, s[40:43], s79 offen offset:0 nt
  buffer_load_dwordx4 v[84:87], v47, s[40:43], s79 offen offset:1024 nt
  buffer_load_dwordx4 v[88:91], v47, s[40:43], s79 offen offset:2048 nt
  buffer_load_dwordx4 v[92:95], v47, s[40:43], s79 offen offset:3072 nt
L_d2v2:
  s_mov_b32 s65, 1
  s_cmp_le_u32 s64, s3
  s_cbranch_scc1 L_d3v2
  s_mov_b64 exec, 1
  ds_add_rtn_u32 v42, v40, v41 offset:0
  ds_read_b32 v58, v40 offset:4
  s_mov_b64 exec, -1
  s_waitcnt lgkmcnt(0)
  v_readfirstlane_b32 s85, v42
  v_readfirstlane_b32 s64, v58
  s_cmp_lt_u32 s85, 128
  s_cselect_b64 s[52:53], s[44:45], s[48:49]
  s_cselect_b64 s[54:55], s[46:47], s[50:51]
  s_bitcmp1_b32 s85, 6
  s_cselect_b64 s[40:41], s[54:55], s[52:53]
  s_lshr_b32 s75, s85, 1
  s_mul_i32 s75, s75, 49152
  s_lshl_b32 s79, s85, 13
  s_add_u32 s79, s79, s75
  buffer_load_dwordx4 v[96:99], v1, s[40:43], s79 offen offset:0 nt
  buffer_load_dwordx4 v[100:103], v1, s[40:43], s79 offen offset:1024 nt
  buffer_load_dwordx4 v[104:107], v1, s[40:43], s79 offen offset:2048 nt
  buffer_load_dwordx4 v[108:111], v1, s[40:43], s79 offen offset:3072 nt
  buffer_load_dwordx4 v[112:115], v47, s[40:43], s79 offen offset:0 nt
  buffer_load_dwordx4 v[116:119], v47, s[40:43], s79 offen offset:1024 nt
  buffer_load_dwordx4 v[120:123], v47, s[40:43], s79 offen offset:2048 nt
  buffer_load_dwordx4 v[124:127], v47, s[40:43], s79 offen offset:3072 nt
  s_mov_b32 s65, 2
L_d3v2:
  s_branch L_v0
L_x0:
  s_mov_b32 s68, 0
  s_branch L_vend
L_x1:
  s_mov_b32 s68, 1
  s_branch L_vend
L_x2:
  s_mov_b32 s68, 2
L_vend:
  s_nop 7
  v_add_f32_dpp v16, v16, v16 quad_perm:[2,3,0,1] row_mask:0xf bank_mask:0xf
  v_add_f32_dpp v17, v17, v17 quad_perm:[2,3,0,1] row_mask:0xf bank_mask:0xf
  v_add_f32_dpp v18, v18, v18 quad_perm:[2,3,0,1] row_mask:0xf bank_mask:0xf
  v_add_f32_dpp v19, v19, v19 quad_perm:[2,3,0,1] row_mask:0xf bank_mask:0xf
  v_and_b32 v12, v16, v2
  v_and_b32 v13, v17, v2
  v_and_b32 v14, v18, v2
  v_and_b32 v15, v19, v2
  v_sub_f32 v16, v16, v12
  v_sub_f32 v17, v17, v13
  v_sub_f32 v18, v18, v14
  v_sub_f32 v19, v19, v15
  ds_write_b16_d16_hi v56, v16 offset:768
  ds_write_b16_d16_hi v56, v17 offset:800
  ds_write_b16_d16_hi v56, v18 offset:776
  ds_write_b16_d16_hi v56, v19 offset:808
  s_cmp_eq_u32 s67, 256
  s_cbranch_scc1 L_sfin
  s_mov_b64 exec, 1
  ds_add_u32 v40, v41 offset:8
  s_mov_b64 exec, -1
  v_mov_b32 v16, 0
  v_mov_b32 v17, 0
  v_mov_b32 v18, 0
  v_mov_b32 v19, 0
  v_mov_b32 v6, 0xff800000
  v_add_u32 v56, 2176, v56
  v_add_u32 v57, 16, v57
  v_mov_b32 v44, 16
  v_mov_b32 v36, 4
  s_mov_b32 s66, 192
  s_mov_b32 s67, 256
L_gqb:
  ds_read_b32 v58, v40 offset:20
  ds_read_b128 v[8:11], v46 offset:512
  s_waitcnt lgkmcnt(0)
  v_readfirstlane_b32 s75, v58
  s_cmp_eq_u32 s75, 0
  s_cbranch_scc1 L_gqb
  s_cmp_eq_u32 s68, 0
  s_cbranch_scc1 L_k0
  s_cmp_eq_u32 s68, 1
  s_cbranch_scc1 L_k1
  s_branch L_k2
L_sfin:
  s_waitcnt lgkmcnt(0)
  s_barrier
  s_branch L_fin
L_helper:
  s_sub_u32 s83, s3, 4
  s_getpc_b64 s[36:37]
L_pc:
  s_sub_u32 s36, s36, L_pc-gated_mix__gqa_block_cached__gqa_block_cached__decode_kernel
  s_subb_u32 s37, s37, 0
  s_lshl_b32 s75, s83, 10
  s_add_u32 s36, s36, s75
  s_addc_u32 s37, s37, 0
  global_load_dwordx4 v[128:131], v1, s[36:37]
  s_add_u32 s36, s36, 4096
  s_addc_u32 s37, s37, 0
  global_load_dwordx4 v[132:135], v1, s[36:37]
  s_add_u32 s36, s36, 4096
  s_addc_u32 s37, s37, 0
  global_load_dwordx4 v[136:139], v1, s[36:37]
  s_add_u32 s36, s36, 4096
  s_addc_u32 s37, s37, 0
  global_load_dwordx4 v[140:143], v1, s[36:37]
  s_add_u32 s36, s36, 4096
  s_addc_u32 s37, s37, 0
  global_load_dwordx4 v[144:147], v1, s[36:37]
  s_add_u32 s36, s36, 4096
  s_addc_u32 s37, s37, 0
  s_mul_i32 s78, s72, 163840
  v_add_u32 v57, 0, v0
  v_mul_u32_u24 v58, 3277, v57
  v_lshrrev_b32 v58, 16, v58
  v_mul_u32_u24 v59, 20, v58
  v_sub_u32 v57, v57, v59
  v_lshlrev_b32 v57, 4, v57
  v_mul_u32_u24 v58, 1280, v58
  v_add_u32 v43, v57, v58
  v_add_u32 v57, 64, v0
  v_mul_u32_u24 v58, 3277, v57
  v_lshrrev_b32 v58, 16, v58
  v_mul_u32_u24 v59, 20, v58
  v_sub_u32 v57, v57, v59
  v_lshlrev_b32 v57, 4, v57
  v_mul_u32_u24 v58, 1280, v58
  v_add_u32 v44, v57, v58
  v_add_u32 v57, 128, v0
  v_mul_u32_u24 v58, 3277, v57
  v_lshrrev_b32 v58, 16, v58
  v_mul_u32_u24 v59, 20, v58
  v_sub_u32 v57, v57, v59
  v_lshlrev_b32 v57, 4, v57
  v_mul_u32_u24 v58, 1280, v58
  v_add_u32 v45, v57, v58
  v_add_u32 v57, 192, v0
  v_mul_u32_u24 v58, 3277, v57
  v_lshrrev_b32 v58, 16, v58
  v_mul_u32_u24 v59, 20, v58
  v_sub_u32 v57, v57, v59
  v_lshlrev_b32 v57, 4, v57
  v_mul_u32_u24 v58, 1280, v58
  v_add_u32 v46, v57, v58
  v_add_u32 v57, 256, v0
  v_mul_u32_u24 v58, 3277, v57
  v_lshrrev_b32 v58, 16, v58
  v_mul_u32_u24 v59, 20, v58
  v_sub_u32 v57, v57, v59
  v_lshlrev_b32 v57, 4, v57
  v_mul_u32_u24 v58, 1280, v58
  v_add_u32 v47, v57, v58
  v_lshrrev_b32 v56, 2, v0
  v_mul_u32_u24 v56, 320, v56
  v_and_b32 v57, 3, v0
  v_lshl_add_u32 v56, v57, 3, v56
  s_mul_i32 s77, s83, 5120
  s_add_u32 s77, s77, 5120
  v_add_u32 v56, s77, v56
  v_mov_b32 v40, 0
  v_mov_b32 v224, 0
  v_mov_b32 v225, 0
  v_mov_b32 v226, 0
  v_mov_b32 v227, 0
  v_mov_b32 v228, 0
  v_mov_b32 v229, 0
  v_mov_b32 v230, 0
  v_mov_b32 v231, 0
  v_mov_b32 v232, 0
  v_mov_b32 v233, 0
  v_mov_b32 v234, 0
  v_mov_b32 v235, 0
  v_mov_b32 v236, 0
  v_mov_b32 v237, 0
  v_mov_b32 v238, 0
  v_mov_b32 v239, 0
  v_mov_b32 v240, 0
  v_mov_b32 v241, 0
  v_mov_b32 v242, 0
  v_mov_b32 v243, 0
  v_mov_b32 v244, 0
  v_mov_b32 v245, 0
  v_mov_b32 v246, 0
  v_mov_b32 v247, 0
  v_mov_b32 v248, 0
  v_mov_b32 v249, 0
  v_mov_b32 v250, 0
  v_mov_b32 v251, 0
  v_mov_b32 v252, 0
  v_mov_b32 v253, 0
  v_mov_b32 v254, 0
  v_mov_b32 v255, 0
  v_and_b32 v39, 7, v0
  v_mul_u32_u24 v39, 272, v39
  v_lshrrev_b32 v57, 4, v0
  v_lshl_add_u32 v39, v57, 4, v39
  v_mov_b32 v41, 0
  v_mov_b32 v32, 0
  v_mov_b32 v33, 0
  v_mov_b32 v34, 0
  v_mov_b32 v35, 1023
  s_mul_i32 s76, s83, 3
  s_add_u32 s76, s76, 16
  s_mul_i32 s74, s2, 2560
  s_mul_i32 s75, s83, 640
  s_add_u32 s74, s74, s75
  s_add_u32 s74, s74, 4096
  v_lshlrev_b32 v42, 3, v0
  v_bfe_u32 v57, v0, 5, 1
  v_lshlrev_b32 v57, 6, v57
  v_and_b32 v58, 12, v0
  v_lshl_add_u32 v57, v58, 2, v57
  v_add_u32 v57, 512, v57
  v_and_b32 v58, 3, v0
  v_cmp_ne_u32 vcc, 1, v58
  s_nop 1
  v_cndmask_b32 v42, v57, v42, vcc
  s_waitcnt lgkmcnt(0)
  s_add_u32 s48, s14, s78
  s_addc_u32 s49, s15, 0
  s_mov_b32 s50, 163840
  s_mov_b32 s51, 0x20000
  s_mov_b32 s60, s30
  s_mov_b32 s61, s31
  s_mov_b32 s62, 1202176
  s_mov_b32 s63, 0x20000
  s_waitcnt vmcnt(0)
  s_mov_b32 s82, 0
L_hloop:
  s_mul_i32 s79, s83, 320
L_wow0:
  ds_read_b32 v57, v40 offset:0
  s_waitcnt lgkmcnt(0)
  v_readfirstlane_b32 s75, v57
  s_cmp_ge_u32 s75, s76
  s_cbranch_scc1 L_wog0
  s_sleep 8
  s_branch L_wow0
L_wog0:
  s_add_u32 m0, s77, 0
  s_nop 0
  buffer_load_dwordx4 v43, s[48:51], s79 offen nt lds
  s_waitcnt vmcnt(1)
  s_add_u32 m0, s77, 1024
  s_nop 0
  buffer_load_dwordx4 v44, s[48:51], s79 offen nt lds
  s_waitcnt vmcnt(1)
  s_add_u32 m0, s77, 2048
  s_nop 0
  buffer_load_dwordx4 v45, s[48:51], s79 offen nt lds
  s_waitcnt vmcnt(1)
  s_add_u32 m0, s77, 3072
  s_nop 0
  buffer_load_dwordx4 v46, s[48:51], s79 offen nt lds
  s_waitcnt vmcnt(1)
  s_add_u32 m0, s77, 4096
  s_nop 0
  buffer_load_dwordx4 v47, s[48:51], s79 offen nt lds
  s_add_u32 s79, s79, 20480
  s_add_u32 s76, s76, 12
  s_waitcnt vmcnt(0)
  ds_read_b64_tr_b16 v[64:65], v56 offset:0
  ds_read_b64_tr_b16 v[80:81], v56 offset:32
  ds_read_b64_tr_b16 v[96:97], v56 offset:64
  ds_read_b64_tr_b16 v[112:113], v56 offset:96
  ds_read_b64_tr_b16 v[128:129], v56 offset:128
  ds_read_b64_tr_b16 v[144:145], v56 offset:160
  ds_read_b64_tr_b16 v[160:161], v56 offset:192
  ds_read_b64_tr_b16 v[176:177], v56 offset:224
  ds_read_b64_tr_b16 v[192:193], v56 offset:256
  ds_read_b64_tr_b16 v[208:209], v56 offset:288
L_wow1:
  ds_read_b32 v57, v40 offset:0
  s_waitcnt lgkmcnt(0)
  v_readfirstlane_b32 s75, v57
  s_cmp_ge_u32 s75, s76
  s_cbranch_scc1 L_wog1
  s_sleep 8
  s_branch L_wow1
L_wog1:
  s_add_u32 m0, s77, 0
  s_nop 0
  buffer_load_dwordx4 v43, s[48:51], s79 offen nt lds
  s_waitcnt vmcnt(1)
  s_add_u32 m0, s77, 1024
  s_nop 0
  buffer_load_dwordx4 v44, s[48:51], s79 offen nt lds
  s_waitcnt vmcnt(1)
  s_add_u32 m0, s77, 2048
  s_nop 0
  buffer_load_dwordx4 v45, s[48:51], s79 offen nt lds
  s_waitcnt vmcnt(1)
  s_add_u32 m0, s77, 3072
  s_nop 0
  buffer_load_dwordx4 v46, s[48:51], s79 offen nt lds
  s_waitcnt vmcnt(1)
  s_add_u32 m0, s77, 4096
  s_nop 0
  buffer_load_dwordx4 v47, s[48:51], s79 offen nt lds
  s_add_u32 s79, s79, 20480
  s_add_u32 s76, s76, 12
  s_waitcnt vmcnt(0)
  ds_read_b64_tr_b16 v[66:67], v56 offset:0
  ds_read_b64_tr_b16 v[82:83], v56 offset:32
  ds_read_b64_tr_b16 v[98:99], v56 offset:64
  ds_read_b64_tr_b16 v[114:115], v56 offset:96
  ds_read_b64_tr_b16 v[130:131], v56 offset:128
  ds_read_b64_tr_b16 v[146:147], v56 offset:160
  ds_read_b64_tr_b16 v[162:163], v56 offset:192
  ds_read_b64_tr_b16 v[178:179], v56 offset:224
  ds_read_b64_tr_b16 v[194:195], v56 offset:256
  ds_read_b64_tr_b16 v[210:211], v56 offset:288
L_wow2:
  ds_read_b32 v57, v40 offset:0
  s_waitcnt lgkmcnt(0)
  v_readfirstlane_b32 s75, v57
  s_cmp_ge_u32 s75, s76
  s_cbranch_scc1 L_wog2
  s_sleep 8
  s_branch L_wow2
L_wog2:
  s_add_u32 m0, s77, 0
  s_nop 0
  buffer_load_dwordx4 v43, s[48:51], s79 offen nt lds
  s_waitcnt vmcnt(1)
  s_add_u32 m0, s77, 1024
  s_nop 0
  buffer_load_dwordx4 v44, s[48:51], s79 offen nt lds
  s_waitcnt vmcnt(1)
  s_add_u32 m0, s77, 2048
  s_nop 0
  buffer_load_dwordx4 v45, s[48:51], s79 offen nt lds
  s_waitcnt vmcnt(1)
  s_add_u32 m0, s77, 3072
  s_nop 0
  buffer_load_dwordx4 v46, s[48:51], s79 offen nt lds
  s_waitcnt vmcnt(1)
  s_add_u32 m0, s77, 4096
  s_nop 0
  buffer_load_dwordx4 v47, s[48:51], s79 offen nt lds
  s_add_u32 s79, s79, 20480
  s_add_u32 s76, s76, 12
  s_waitcnt vmcnt(0)
  ds_read_b64_tr_b16 v[68:69], v56 offset:0
  ds_read_b64_tr_b16 v[84:85], v56 offset:32
  ds_read_b64_tr_b16 v[100:101], v56 offset:64
  ds_read_b64_tr_b16 v[116:117], v56 offset:96
  ds_read_b64_tr_b16 v[132:133], v56 offset:128
  ds_read_b64_tr_b16 v[148:149], v56 offset:160
  ds_read_b64_tr_b16 v[164:165], v56 offset:192
  ds_read_b64_tr_b16 v[180:181], v56 offset:224
  ds_read_b64_tr_b16 v[196:197], v56 offset:256
  ds_read_b64_tr_b16 v[212:213], v56 offset:288
L_wow3:
  ds_read_b32 v57, v40 offset:0
  s_waitcnt lgkmcnt(0)
  v_readfirstlane_b32 s75, v57
  s_cmp_ge_u32 s75, s76
  s_cbranch_scc1 L_wog3
  s_sleep 8
  s_branch L_wow3
L_wog3:
  s_add_u32 m0, s77, 0
  s_nop 0
  buffer_load_dwordx4 v43, s[48:51], s79 offen nt lds
  s_waitcnt vmcnt(1)
  s_add_u32 m0, s77, 1024
  s_nop 0
  buffer_load_dwordx4 v44, s[48:51], s79 offen nt lds
  s_waitcnt vmcnt(1)
  s_add_u32 m0, s77, 2048
  s_nop 0
  buffer_load_dwordx4 v45, s[48:51], s79 offen nt lds
  s_waitcnt vmcnt(1)
  s_add_u32 m0, s77, 3072
  s_nop 0
  buffer_load_dwordx4 v46, s[48:51], s79 offen nt lds
  s_waitcnt vmcnt(1)
  s_add_u32 m0, s77, 4096
  s_nop 0
  buffer_load_dwordx4 v47, s[48:51], s79 offen nt lds
  s_add_u32 s79, s79, 20480
  s_add_u32 s76, s76, 12
  s_waitcnt vmcnt(0)
  ds_read_b64_tr_b16 v[70:71], v56 offset:0
  ds_read_b64_tr_b16 v[86:87], v56 offset:32
  ds_read_b64_tr_b16 v[102:103], v56 offset:64
  ds_read_b64_tr_b16 v[118:119], v56 offset:96
  ds_read_b64_tr_b16 v[134:135], v56 offset:128
  ds_read_b64_tr_b16 v[150:151], v56 offset:160
  ds_read_b64_tr_b16 v[166:167], v56 offset:192
  ds_read_b64_tr_b16 v[182:183], v56 offset:224
  ds_read_b64_tr_b16 v[198:199], v56 offset:256
  ds_read_b64_tr_b16 v[214:215], v56 offset:288
L_wow4:
  ds_read_b32 v57, v40 offset:0
  s_waitcnt lgkmcnt(0)
  v_readfirstlane_b32 s75, v57
  s_cmp_ge_u32 s75, s76
  s_cbranch_scc1 L_wog4
  s_sleep 8
  s_branch L_wow4
L_wog4:
  s_add_u32 m0, s77, 0
  s_nop 0
  buffer_load_dwordx4 v43, s[48:51], s79 offen nt lds
  s_waitcnt vmcnt(1)
  s_add_u32 m0, s77, 1024
  s_nop 0
  buffer_load_dwordx4 v44, s[48:51], s79 offen nt lds
  s_waitcnt vmcnt(1)
  s_add_u32 m0, s77, 2048
  s_nop 0
  buffer_load_dwordx4 v45, s[48:51], s79 offen nt lds
  s_waitcnt vmcnt(1)
  s_add_u32 m0, s77, 3072
  s_nop 0
  buffer_load_dwordx4 v46, s[48:51], s79 offen nt lds
  s_waitcnt vmcnt(1)
  s_add_u32 m0, s77, 4096
  s_nop 0
  buffer_load_dwordx4 v47, s[48:51], s79 offen nt lds
  s_add_u32 s79, s79, 20480
  s_add_u32 s76, s76, 12
  s_waitcnt vmcnt(0)
  ds_read_b64_tr_b16 v[72:73], v56 offset:0
  ds_read_b64_tr_b16 v[88:89], v56 offset:32
  ds_read_b64_tr_b16 v[104:105], v56 offset:64
  ds_read_b64_tr_b16 v[120:121], v56 offset:96
  ds_read_b64_tr_b16 v[136:137], v56 offset:128
  ds_read_b64_tr_b16 v[152:153], v56 offset:160
  ds_read_b64_tr_b16 v[168:169], v56 offset:192
  ds_read_b64_tr_b16 v[184:185], v56 offset:224
  ds_read_b64_tr_b16 v[200:201], v56 offset:256
  ds_read_b64_tr_b16 v[216:217], v56 offset:288
L_wow5:
  ds_read_b32 v57, v40 offset:0
  s_waitcnt lgkmcnt(0)
  v_readfirstlane_b32 s75, v57
  s_cmp_ge_u32 s75, s76
  s_cbranch_scc1 L_wog5
  s_sleep 8
  s_branch L_wow5
L_wog5:
  s_add_u32 m0, s77, 0
  s_nop 0
  buffer_load_dwordx4 v43, s[48:51], s79 offen nt lds
  s_waitcnt vmcnt(1)
  s_add_u32 m0, s77, 1024
  s_nop 0
  buffer_load_dwordx4 v44, s[48:51], s79 offen nt lds
  s_waitcnt vmcnt(1)
  s_add_u32 m0, s77, 2048
  s_nop 0
  buffer_load_dwordx4 v45, s[48:51], s79 offen nt lds
  s_waitcnt vmcnt(1)
  s_add_u32 m0, s77, 3072
  s_nop 0
  buffer_load_dwordx4 v46, s[48:51], s79 offen nt lds
  s_waitcnt vmcnt(1)
  s_add_u32 m0, s77, 4096
  s_nop 0
  buffer_load_dwordx4 v47, s[48:51], s79 offen nt lds
  s_add_u32 s79, s79, 20480
  s_add_u32 s76, s76, 12
  s_waitcnt vmcnt(0)
  ds_read_b64_tr_b16 v[74:75], v56 offset:0
  ds_read_b64_tr_b16 v[90:91], v56 offset:32
  ds_read_b64_tr_b16 v[106:107], v56 offset:64
  ds_read_b64_tr_b16 v[122:123], v56 offset:96
  ds_read_b64_tr_b16 v[138:139], v56 offset:128
  ds_read_b64_tr_b16 v[154:155], v56 offset:160
  ds_read_b64_tr_b16 v[170:171], v56 offset:192
  ds_read_b64_tr_b16 v[186:187], v56 offset:224
  ds_read_b64_tr_b16 v[202:203], v56 offset:256
  ds_read_b64_tr_b16 v[218:219], v56 offset:288
L_wow6:
  ds_read_b32 v57, v40 offset:0
  s_waitcnt lgkmcnt(0)
  v_readfirstlane_b32 s75, v57
  s_cmp_ge_u32 s75, s76
  s_cbranch_scc1 L_wog6
  s_sleep 8
  s_branch L_wow6
L_wog6:
  s_add_u32 m0, s77, 0
  s_nop 0
  buffer_load_dwordx4 v43, s[48:51], s79 offen nt lds
  s_waitcnt vmcnt(1)
  s_add_u32 m0, s77, 1024
  s_nop 0
  buffer_load_dwordx4 v44, s[48:51], s79 offen nt lds
  s_waitcnt vmcnt(1)
  s_add_u32 m0, s77, 2048
  s_nop 0
  buffer_load_dwordx4 v45, s[48:51], s79 offen nt lds
  s_waitcnt vmcnt(1)
  s_add_u32 m0, s77, 3072
  s_nop 0
  buffer_load_dwordx4 v46, s[48:51], s79 offen nt lds
  s_waitcnt vmcnt(1)
  s_add_u32 m0, s77, 4096
  s_nop 0
  buffer_load_dwordx4 v47, s[48:51], s79 offen nt lds
  s_add_u32 s79, s79, 20480
  s_add_u32 s76, s76, 12
  s_waitcnt vmcnt(0)
  ds_read_b64_tr_b16 v[76:77], v56 offset:0
  ds_read_b64_tr_b16 v[92:93], v56 offset:32
  ds_read_b64_tr_b16 v[108:109], v56 offset:64
  ds_read_b64_tr_b16 v[124:125], v56 offset:96
  ds_read_b64_tr_b16 v[140:141], v56 offset:128
  ds_read_b64_tr_b16 v[156:157], v56 offset:160
  ds_read_b64_tr_b16 v[172:173], v56 offset:192
  ds_read_b64_tr_b16 v[188:189], v56 offset:224
  ds_read_b64_tr_b16 v[204:205], v56 offset:256
  ds_read_b64_tr_b16 v[220:221], v56 offset:288
L_wow7:
  ds_read_b32 v57, v40 offset:0
  s_waitcnt lgkmcnt(0)
  v_readfirstlane_b32 s75, v57
  s_cmp_ge_u32 s75, s76
  s_cbranch_scc1 L_wog7
  s_sleep 8
  s_branch L_wow7
L_wog7:
  s_add_u32 m0, s77, 0
  s_nop 0
  buffer_load_dwordx4 v43, s[48:51], s79 offen nt lds
  s_waitcnt vmcnt(1)
  s_add_u32 m0, s77, 1024
  s_nop 0
  buffer_load_dwordx4 v44, s[48:51], s79 offen nt lds
  s_waitcnt vmcnt(1)
  s_add_u32 m0, s77, 2048
  s_nop 0
  buffer_load_dwordx4 v45, s[48:51], s79 offen nt lds
  s_waitcnt vmcnt(1)
  s_add_u32 m0, s77, 3072
  s_nop 0
  buffer_load_dwordx4 v46, s[48:51], s79 offen nt lds
  s_waitcnt vmcnt(1)
  s_add_u32 m0, s77, 4096
  s_nop 0
  buffer_load_dwordx4 v47, s[48:51], s79 offen nt lds
  s_add_u32 s79, s79, 20480
  s_add_u32 s76, s76, 12
  s_waitcnt vmcnt(0)
  ds_read_b64_tr_b16 v[78:79], v56 offset:0
  ds_read_b64_tr_b16 v[94:95], v56 offset:32
  ds_read_b64_tr_b16 v[110:111], v56 offset:64
  ds_read_b64_tr_b16 v[126:127], v56 offset:96
  ds_read_b64_tr_b16 v[142:143], v56 offset:128
  ds_read_b64_tr_b16 v[158:159], v56 offset:160
  ds_read_b64_tr_b16 v[174:175], v56 offset:192
  ds_read_b64_tr_b16 v[190:191], v56 offset:224
  ds_read_b64_tr_b16 v[206:207], v56 offset:256
  ds_read_b64_tr_b16 v[222:223], v56 offset:288
  s_add_u32 s76, s76, 32
  s_waitcnt lgkmcnt(0)
  s_cmp_lg_u32 s82, 0
  s_cbranch_scc1 L_hb3
L_hwa:
  s_sleep 8
  ds_read_b32 v36, v40 offset:8
  ds_read_b32 v37, v40 offset:128
  s_waitcnt lgkmcnt(0)
  v_readfirstlane_b32 s75, v36
  v_readfirstlane_b32 s78, v37
  s_cmp_lt_u32 s75, 3
  s_cbranch_scc1 L_hwa
  s_cmp_eq_u32 s78, -1
  s_cbranch_scc1 L_hwa
  ds_read_b128 v[48:51], v40 offset:144
  s_waitcnt lgkmcnt(0)
  s_mov_b32 exec_lo, 0x3f003f
  s_mov_b32 exec_hi, 0x3f003f
  s_branch L_proj
L_hb3:
  s_setprio 2
  s_mov_b32 exec_lo, 0x3f003f
  s_mov_b32 exec_hi, 0x3f003f
  s_barrier
L_proj:
  ds_read_b128 v[224:227], v39 offset:768
  ds_read_b128 v[228:231], v39 offset:832
  ds_read_b128 v[232:235], v39 offset:896
  ds_read_b128 v[236:239], v39 offset:960
  s_mov_b32 exec_lo, 0x3f003f00
  s_mov_b32 exec_hi, 0x3f003f00
  ds_read_b128 v[240:243], v39 offset:768
  ds_read_b128 v[244:247], v39 offset:832
  ds_read_b128 v[248:251], v39 offset:896
  ds_read_b128 v[252:255], v39 offset:960
  s_mov_b64 exec, -1
  ds_read_b32 v59, v41 offset:128
  s_waitcnt lgkmcnt(8)
  v_mfma_f32_16x16x32_bf16 v[4:7], v[224:227], v[64:67], 0
  v_mfma_f32_16x16x32_bf16 v[8:11], v[224:227], v[96:99], 0
  v_mfma_f32_16x16x32_bf16 v[12:15], v[224:227], v[128:131], 0
  v_mfma_f32_16x16x32_bf16 v[16:19], v[224:227], v[160:163], 0
  v_mfma_f32_16x16x32_bf16 v[20:23], v[224:227], v[192:195], 0
  s_waitcnt lgkmcnt(7)
  v_mfma_f32_16x16x32_bf16 v[4:7], v[228:231], v[68:71], v[4:7]
  v_mfma_f32_16x16x32_bf16 v[8:11], v[228:231], v[100:103], v[8:11]
  v_mfma_f32_16x16x32_bf16 v[12:15], v[228:231], v[132:135], v[12:15]
  v_mfma_f32_16x16x32_bf16 v[16:19], v[228:231], v[164:167], v[16:19]
  v_mfma_f32_16x16x32_bf16 v[20:23], v[228:231], v[196:199], v[20:23]
  s_waitcnt lgkmcnt(6)
  v_mfma_f32_16x16x32_bf16 v[4:7], v[232:235], v[72:75], v[4:7]
  v_mfma_f32_16x16x32_bf16 v[8:11], v[232:235], v[104:107], v[8:11]
  v_mfma_f32_16x16x32_bf16 v[12:15], v[232:235], v[136:139], v[12:15]
  v_mfma_f32_16x16x32_bf16 v[16:19], v[232:235], v[168:171], v[16:19]
  v_mfma_f32_16x16x32_bf16 v[20:23], v[232:235], v[200:203], v[20:23]
  s_waitcnt lgkmcnt(5)
  v_mfma_f32_16x16x32_bf16 v[4:7], v[236:239], v[76:79], v[4:7]
  v_mfma_f32_16x16x32_bf16 v[8:11], v[236:239], v[108:111], v[8:11]
  v_mfma_f32_16x16x32_bf16 v[12:15], v[236:239], v[140:143], v[12:15]
  v_mfma_f32_16x16x32_bf16 v[16:19], v[236:239], v[172:175], v[16:19]
  v_mfma_f32_16x16x32_bf16 v[20:23], v[236:239], v[204:207], v[20:23]
  s_waitcnt lgkmcnt(4)
  v_mfma_f32_16x16x32_bf16 v[4:7], v[240:243], v[80:83], v[4:7]
  v_mfma_f32_16x16x32_bf16 v[8:11], v[240:243], v[112:115], v[8:11]
  v_mfma_f32_16x16x32_bf16 v[12:15], v[240:243], v[144:147], v[12:15]
  v_mfma_f32_16x16x32_bf16 v[16:19], v[240:243], v[176:179], v[16:19]
  v_mfma_f32_16x16x32_bf16 v[20:23], v[240:243], v[208:211], v[20:23]
  s_waitcnt lgkmcnt(3)
  v_mfma_f32_16x16x32_bf16 v[4:7], v[244:247], v[84:87], v[4:7]
  v_mfma_f32_16x16x32_bf16 v[8:11], v[244:247], v[116:119], v[8:11]
  v_mfma_f32_16x16x32_bf16 v[12:15], v[244:247], v[148:151], v[12:15]
  v_mfma_f32_16x16x32_bf16 v[16:19], v[244:247], v[180:183], v[16:19]
  v_mfma_f32_16x16x32_bf16 v[20:23], v[244:247], v[212:215], v[20:23]
  s_waitcnt lgkmcnt(2)
  v_mfma_f32_16x16x32_bf16 v[4:7], v[248:251], v[88:91], v[4:7]
  v_mfma_f32_16x16x32_bf16 v[8:11], v[248:251], v[120:123], v[8:11]
  v_mfma_f32_16x16x32_bf16 v[12:15], v[248:251], v[152:155], v[12:15]
  v_mfma_f32_16x16x32_bf16 v[16:19], v[248:251], v[184:187], v[16:19]
  v_mfma_f32_16x16x32_bf16 v[20:23], v[248:251], v[216:219], v[20:23]
  s_waitcnt lgkmcnt(1)
  v_mfma_f32_16x16x32_bf16 v[4:7], v[252:255], v[92:95], v[4:7]
  v_mfma_f32_16x16x32_bf16 v[8:11], v[252:255], v[124:127], v[8:11]
  v_mfma_f32_16x16x32_bf16 v[12:15], v[252:255], v[156:159], v[12:15]
  v_mfma_f32_16x16x32_bf16 v[16:19], v[252:255], v[188:191], v[16:19]
  v_mfma_f32_16x16x32_bf16 v[20:23], v[252:255], v[220:223], v[20:23]
  s_nop 3
  v_add_f32 v4, v4, v5
  v_add_f32 v6, v6, v7
  s_nop 0
  v_add_f32 v8, v8, v9
  v_add_f32 v10, v10, v11
  s_nop 0
  v_add_f32 v12, v12, v13
  v_add_f32 v14, v14, v15
  v_add_f32 v16, v16, v17
  v_add_f32 v18, v18, v19
  v_add_f32 v20, v20, v21
  v_add_f32 v22, v22, v23
  v_add_f32 v24, v4, v6
  v_add_f32 v28, v8, v10
  v_add_f32 v25, v12, v14
  v_add_f32 v29, v16, v18
  v_add_f32 v26, v20, v22
  v_add_f32 v30, v20, v22
  s_waitcnt lgkmcnt(0)
  v_permlane16_swap_b32 v24, v28
  v_permlane16_swap_b32 v25, v29
  v_permlane16_swap_b32 v26, v30
  s_nop 0
  v_fmac_f32 v32, v59, v24
  v_fmac_f32 v33, v59, v25
  v_fmac_f32 v34, v59, v26
  v_fmac_f32 v32, v59, v28
  v_fmac_f32 v33, v59, v29
  v_fmac_f32 v34, v59, v30
  v_mov_b32_dpp v30, v32 quad_perm:[1,1,3,3] row_mask:0xf bank_mask:0xf
  v_mov_b32_dpp v31, v33 quad_perm:[1,1,3,3] row_mask:0xf bank_mask:0xf
  v_cndmask_b32_dpp v28, v34, v32, vcc quad_perm:[0,0,0,0] row_mask:0xf bank_mask:0xf
  v_cndmask_b32_dpp v29, v34, v33, vcc quad_perm:[1,1,1,1] row_mask:0xf bank_mask:0xf
  v_cndmask_b32_dpp v30, v34, v30, vcc quad_perm:[2,2,2,2] row_mask:0xf bank_mask:0xf
  v_cndmask_b32_dpp v31, v34, v31, vcc quad_perm:[3,3,3,3] row_mask:0xf bank_mask:0xf
  v_bfi_b32 v28, v35, v48, v28
  v_bfi_b32 v29, v35, v49, v29
  v_bfi_b32 v30, v35, v50, v30
  v_bfi_b32 v31, v35, v51, v31
  s_cmp_lg_u32 s82, 0
  s_cbranch_scc1 L_hst
  s_mov_b32 s82, 1
  v_add_u32 v39, 2176, v39
  v_mov_b32 v41, 4
  s_mul_i32 s78, s72, 163840
  s_add_u32 s48, s22, s78
  s_addc_u32 s49, s23, 0
  s_branch L_hloop
L_hst:
  s_mov_b32 exec_lo, 0x55557777
  s_mov_b32 exec_hi, 0x55557777
  buffer_store_dwordx4 v[28:31], v42, s[60:63], s74 offen sc1
  s_barrier
  s_branch L_fin
L_service:
  s_setprio 2
  s_lshl_b32 s41, s72, 8
  v_lshrrev_b32 v45, 4, v0
  v_and_b32 v46, 15, v0
  v_mul_u32_u24 v47, 163840, v45
  v_lshl_add_u32 v47, v46, 4, v47
  v_mul_u32_u24 v57, 40, v45
  s_mul_i32 s76, s73, 160
  s_mul_i32 s42, s73, 655360
  s_mov_b32 s79, s42
  s_waitcnt lgkmcnt(0)
  s_load_dwordx2 s[64:65], s[30:31], 0
  s_mov_b32 s52, s4
  s_mov_b32 s53, s5
  s_mov_b32 s54, 1280
  s_mov_b32 s55, 0x20000
  s_add_u32 s44, s12, s41
  s_addc_u32 s45, s13, 0
  s_mov_b32 s46, 0
  s_mov_b32 s47, 0x20000
  s_sub_u32 s46, 5242880, s41
  buffer_load_dwordx4 v[224:227], v57, s[52:55], s76 offen
  buffer_load_dwordx4 v[228:231], v57, s[52:55], s76 offen offset:16
  buffer_load_dwordx2 v[232:233], v57, s[52:55], s76 offen offset:32
  s_mov_b32 s40, 0
L_qloop:
  buffer_load_dwordx4 v[64:67], v47, s[44:47], s79 offen nt
  s_add_u32 s79, s79, 8192
  buffer_load_dwordx4 v[68:71], v47, s[44:47], s79 offen nt
  s_add_u32 s79, s79, 8192
  buffer_load_dwordx4 v[72:75], v47, s[44:47], s79 offen nt
  s_add_u32 s79, s79, 8192
  buffer_load_dwordx4 v[76:79], v47, s[44:47], s79 offen nt
  s_add_u32 s79, s79, 8192
  s_cmp_eq_u32 s40, 0
  s_cbranch_scc1 L_qs4
  s_waitcnt vmcnt(0)
L_qs4:
  buffer_load_dwordx4 v[80:83], v47, s[44:47], s79 offen nt
  s_add_u32 s79, s79, 8192
  buffer_load_dwordx4 v[84:87], v47, s[44:47], s79 offen nt
  s_add_u32 s79, s79, 8192
  buffer_load_dwordx4 v[88:91], v47, s[44:47], s79 offen nt
  s_add_u32 s79, s79, 8192
  buffer_load_dwordx4 v[92:95], v47, s[44:47], s79 offen nt
  s_add_u32 s79, s79, 8192
  s_cmp_eq_u32 s40, 0
  s_cbranch_scc1 L_qs8
  s_waitcnt vmcnt(0)
L_qs8:
  buffer_load_dwordx4 v[96:99], v47, s[44:47], s79 offen nt
  s_add_u32 s79, s79, 8192
  buffer_load_dwordx4 v[100:103], v47, s[44:47], s79 offen nt
  s_add_u32 s79, s79, 8192
  buffer_load_dwordx4 v[104:107], v47, s[44:47], s79 offen nt
  s_add_u32 s79, s79, 8192
  buffer_load_dwordx4 v[108:111], v47, s[44:47], s79 offen nt
  s_add_u32 s79, s79, 8192
  s_cmp_eq_u32 s40, 0
  s_cbranch_scc1 L_qs12
  s_waitcnt vmcnt(0)
L_qs12:
  buffer_load_dwordx4 v[112:115], v47, s[44:47], s79 offen nt
  s_add_u32 s79, s79, 8192
  buffer_load_dwordx4 v[116:119], v47, s[44:47], s79 offen nt
  s_add_u32 s79, s79, 8192
  buffer_load_dwordx4 v[120:123], v47, s[44:47], s79 offen nt
  s_add_u32 s79, s79, 8192
  buffer_load_dwordx4 v[124:127], v47, s[44:47], s79 offen nt
  s_add_u32 s79, s79, 8192
  s_cmp_eq_u32 s40, 0
  s_cbranch_scc1 L_qs16
  s_waitcnt vmcnt(0)
L_qs16:
  buffer_load_dwordx4 v[128:131], v47, s[44:47], s79 offen nt
  s_add_u32 s79, s79, 8192
  buffer_load_dwordx4 v[132:135], v47, s[44:47], s79 offen nt
  s_add_u32 s79, s79, 8192
  buffer_load_dwordx4 v[136:139], v47, s[44:47], s79 offen nt
  s_add_u32 s79, s79, 8192
  buffer_load_dwordx4 v[140:143], v47, s[44:47], s79 offen nt
  s_add_u32 s79, s79, 8192
  s_cmp_lg_u32 s40, 0
  s_cbranch_scc1 L_q2
  s_mov_b32 s60, s30
  s_mov_b32 s61, s31
  s_mov_b32 s62, 1202176
  s_mov_b32 s63, 0x20000
  s_mul_i32 s67, s72, 8448
  s_add_u32 s67, s67, 659456
  s_lshl_b32 s75, s73, 10
  s_add_u32 s43, s75, s67
  s_getreg_b32 s75, hwreg(HW_REG_XCC_ID)
  s_and_b32 s75, s75, 15
  s_waitcnt lgkmcnt(0)
  v_mov_b32 v32, s64
  v_mov_b32 v33, s64
  v_mov_b32 v34, s64
  v_mov_b32 v35, s64
  s_add_u32 s64, s64, 1
  s_add_u32 s65, s65, 16
  s_andn2_b32 s76, s65, 15
  s_or_b32 s76, s76, s75
  v_mov_b32 v58, s64
  v_mov_b32 v59, s76
  v_mov_b32 v29, s64
  v_mov_b32 v31, s76
L_q2:
  buffer_store_dwordx4 v[32:35], v1, s[60:63], s43 offen
  s_cmp_lg_u32 s40, 0
  s_cbranch_scc1 L_q3
  v_and_b32 v43, 3, v0
  v_cmp_lt_u32 vcc, 1, v43
  v_mov_b32 v2, 0
  v_mov_b32 v7, 0xffff0000
  v_cndmask_b32 v2, v2, v7, vcc
  v_and_b32 v43, 1, v0
  v_cmp_eq_u32 vcc, 1, v43
  v_mov_b32 v3, 0x0c0c0302
  v_mov_b32 v7, 0x03020c0c
  v_cndmask_b32 v3, v3, v7, vcc
  v_mov_b32 v7, 0x0c0c0100
  v_mov_b32 v44, 0x01000c0c
  v_cndmask_b32 v7, v7, v44, vcc
  v_mov_b32 v48, 0x0c0c0c0c
  v_mov_b32 v52, 0x0c0c0c0c
  v_mov_b32 v49, 0x0c0c0c0c
  v_mov_b32 v53, 0x0c0c0c0c
  v_mov_b32 v50, 0x0c0c0c0c
  v_mov_b32 v54, 0x0c0c0c0c
  v_mov_b32 v51, 0x0c0c0c0c
  v_mov_b32 v55, 0x0c0c0c0c
  v_mov_b32_dpp v48, v3 quad_perm:[0,1,2,3] row_mask:0xf bank_mask:0x1
  v_mov_b32_dpp v52, v7 quad_perm:[0,1,2,3] row_mask:0xf bank_mask:0x1
  v_mov_b32_dpp v49, v3 quad_perm:[0,1,2,3] row_mask:0xf bank_mask:0x2
  v_mov_b32_dpp v53, v7 quad_perm:[0,1,2,3] row_mask:0xf bank_mask:0x2
  v_mov_b32_dpp v50, v3 quad_perm:[0,1,2,3] row_mask:0xf bank_mask:0x4
  v_mov_b32_dpp v54, v7 quad_perm:[0,1,2,3] row_mask:0xf bank_mask:0x4
  v_mov_b32_dpp v51, v3 quad_perm:[0,1,2,3] row_mask:0xf bank_mask:0x8
  v_mov_b32_dpp v55, v7 quad_perm:[0,1,2,3] row_mask:0xf bank_mask:0x8
  s_mov_b32 s56, s24
  s_mov_b32 s57, s25
  s_mov_b32 s58, 1280
  s_mov_b32 s59, 0x20000
  s_mov_b32 s68, s26
  s_mov_b32 s69, s27
  s_mov_b32 s70, 1280
  s_mov_b32 s71, 0x20000
  v_lshlrev_b32 v56, 5, v45
  v_bfe_u32 v43, v0, 2, 2
  v_lshl_add_u32 v56, v43, 1, v56
  v_bfe_u32 v43, v0, 1, 1
  v_lshl_add_u32 v56, v43, 4, v56
  v_and_b32 v43, 1, v0
  v_add_lshl_u32 v56, v56, v43, 1
  v_mov_b32 v40, 0
  v_mov_b32 v4, 0x3e0293ee
  v_add_u32 v39, 4096, v1
  v_bfe_u32 v60, v58, 0, 10
  v_bfe_u32 v61, v58, 10, 10
  v_bfe_u32 v62, v58, 20, 10
  v_bfe_u32 v63, v59, 4, 10
  ds_write_b128 v40, v[60:63] offset:144
  v_mov_b32 v41, 1
  v_mov_b32 v42, 0
  s_waitcnt vmcnt(21)
  v_cmp_eq_u32 vcc, 0, v2
  s_nop 1
  v_cndmask_b32 v224, 0, v224, vcc
  v_cndmask_b32 v225, 0, v225, vcc
  v_cndmask_b32 v226, 0, v226, vcc
  v_cndmask_b32 v227, 0, v227, vcc
  v_cndmask_b32 v228, 0, v228, vcc
  v_cndmask_b32 v229, 0, v229, vcc
  v_cndmask_b32 v230, 0, v230, vcc
  v_cndmask_b32 v231, 0, v231, vcc
  v_cndmask_b32 v232, 0, v232, vcc
  v_cndmask_b32 v233, 0, v233, vcc
L_q3:
  v_perm_b32 v20, v224, v224, v52
  v_perm_b32 v21, v224, v224, v53
  v_perm_b32 v22, v224, v224, v54
  v_perm_b32 v23, v224, v224, v55
  v_perm_b32 v24, v224, v224, v48
  v_perm_b32 v25, v224, v224, v49
  v_perm_b32 v26, v224, v224, v50
  v_perm_b32 v27, v224, v224, v51
  s_waitcnt vmcnt(19)
  v_mfma_f32_16x16x32_bf16 v[16:19], v[64:67], v[20:23], 0
  v_perm_b32 v20, v225, v225, v52
  v_perm_b32 v21, v225, v225, v53
  v_perm_b32 v22, v225, v225, v54
  v_perm_b32 v23, v225, v225, v55
  v_mfma_f32_16x16x32_bf16 v[16:19], v[68:71], v[24:27], v[16:19]
  v_perm_b32 v24, v225, v225, v48
  v_perm_b32 v25, v225, v225, v49
  v_perm_b32 v26, v225, v225, v50
  v_perm_b32 v27, v225, v225, v51
  s_waitcnt vmcnt(17)
  v_mfma_f32_16x16x32_bf16 v[16:19], v[72:75], v[20:23], v[16:19]
  v_perm_b32 v20, v226, v226, v52
  v_perm_b32 v21, v226, v226, v53
  v_perm_b32 v22, v226, v226, v54
  v_perm_b32 v23, v226, v226, v55
  v_mfma_f32_16x16x32_bf16 v[16:19], v[76:79], v[24:27], v[16:19]
  v_perm_b32 v24, v226, v226, v48
  v_perm_b32 v25, v226, v226, v49
  v_perm_b32 v26, v226, v226, v50
  v_perm_b32 v27, v226, v226, v51
  s_waitcnt vmcnt(15)
  v_mfma_f32_16x16x32_bf16 v[16:19], v[80:83], v[20:23], v[16:19]
  v_perm_b32 v20, v227, v227, v52
  v_perm_b32 v21, v227, v227, v53
  v_perm_b32 v22, v227, v227, v54
  v_perm_b32 v23, v227, v227, v55
  v_mfma_f32_16x16x32_bf16 v[16:19], v[84:87], v[24:27], v[16:19]
  v_perm_b32 v24, v227, v227, v48
  v_perm_b32 v25, v227, v227, v49
  v_perm_b32 v26, v227, v227, v50
  v_perm_b32 v27, v227, v227, v51
  s_waitcnt vmcnt(13)
  v_mfma_f32_16x16x32_bf16 v[16:19], v[88:91], v[20:23], v[16:19]
  v_perm_b32 v20, v228, v228, v52
  v_perm_b32 v21, v228, v228, v53
  v_perm_b32 v22, v228, v228, v54
  v_perm_b32 v23, v228, v228, v55
  v_mfma_f32_16x16x32_bf16 v[16:19], v[92:95], v[24:27], v[16:19]
  v_perm_b32 v24, v228, v228, v48
  v_perm_b32 v25, v228, v228, v49
  v_perm_b32 v26, v228, v228, v50
  v_perm_b32 v27, v228, v228, v51
  s_waitcnt vmcnt(11)
  v_mfma_f32_16x16x32_bf16 v[16:19], v[96:99], v[20:23], v[16:19]
  v_perm_b32 v20, v229, v229, v52
  v_perm_b32 v21, v229, v229, v53
  v_perm_b32 v22, v229, v229, v54
  v_perm_b32 v23, v229, v229, v55
  v_mfma_f32_16x16x32_bf16 v[16:19], v[100:103], v[24:27], v[16:19]
  v_perm_b32 v24, v229, v229, v48
  v_perm_b32 v25, v229, v229, v49
  v_perm_b32 v26, v229, v229, v50
  v_perm_b32 v27, v229, v229, v51
  s_waitcnt vmcnt(9)
  v_mfma_f32_16x16x32_bf16 v[16:19], v[104:107], v[20:23], v[16:19]
  v_perm_b32 v20, v230, v230, v52
  v_perm_b32 v21, v230, v230, v53
  v_perm_b32 v22, v230, v230, v54
  v_perm_b32 v23, v230, v230, v55
  v_mfma_f32_16x16x32_bf16 v[16:19], v[108:111], v[24:27], v[16:19]
  v_perm_b32 v24, v230, v230, v48
  v_perm_b32 v25, v230, v230, v49
  v_perm_b32 v26, v230, v230, v50
  v_perm_b32 v27, v230, v230, v51
  s_waitcnt vmcnt(7)
  v_mfma_f32_16x16x32_bf16 v[16:19], v[112:115], v[20:23], v[16:19]
  v_perm_b32 v20, v231, v231, v52
  v_perm_b32 v21, v231, v231, v53
  v_perm_b32 v22, v231, v231, v54
  v_perm_b32 v23, v231, v231, v55
  v_mfma_f32_16x16x32_bf16 v[16:19], v[116:119], v[24:27], v[16:19]
  v_perm_b32 v24, v231, v231, v48
  v_perm_b32 v25, v231, v231, v49
  v_perm_b32 v26, v231, v231, v50
  v_perm_b32 v27, v231, v231, v51
  s_waitcnt vmcnt(5)
  v_mfma_f32_16x16x32_bf16 v[16:19], v[120:123], v[20:23], v[16:19]
  v_perm_b32 v20, v232, v232, v52
  v_perm_b32 v21, v232, v232, v53
  v_perm_b32 v22, v232, v232, v54
  v_perm_b32 v23, v232, v232, v55
  v_mfma_f32_16x16x32_bf16 v[16:19], v[124:127], v[24:27], v[16:19]
  v_perm_b32 v24, v232, v232, v48
  v_perm_b32 v25, v232, v232, v49
  v_perm_b32 v26, v232, v232, v50
  v_perm_b32 v27, v232, v232, v51
  s_waitcnt vmcnt(3)
  v_mfma_f32_16x16x32_bf16 v[16:19], v[128:131], v[20:23], v[16:19]
  v_perm_b32 v20, v233, v233, v52
  v_perm_b32 v21, v233, v233, v53
  v_perm_b32 v22, v233, v233, v54
  v_perm_b32 v23, v233, v233, v55
  v_mfma_f32_16x16x32_bf16 v[16:19], v[132:135], v[24:27], v[16:19]
  v_perm_b32 v24, v233, v233, v48
  v_perm_b32 v25, v233, v233, v49
  v_perm_b32 v26, v233, v233, v50
  v_perm_b32 v27, v233, v233, v51
  s_waitcnt vmcnt(1)
  v_mfma_f32_16x16x32_bf16 v[16:19], v[136:139], v[20:23], v[16:19]
  s_nop 1
  v_mfma_f32_16x16x32_bf16 v[16:19], v[140:143], v[24:27], v[16:19]
  s_mov_b32 s82, 0
  v_cmp_eq_u32 vcc, 0, v2
  s_nop 5
  v_mov_b32_dpp v28, v18 quad_perm:[0,1,0,1] row_mask:0xf bank_mask:0xf
  v_mov_b32_dpp v30, v19 quad_perm:[0,1,0,1] row_mask:0xf bank_mask:0xf
  v_cndmask_b32 v28, v28, v16, vcc
  v_cndmask_b32 v30, v30, v17, vcc
  buffer_store_dwordx4 v[28:31], v1, s[60:63], s43 offen
L_qpoll:
  s_add_u32 s82, s82, 1
  s_cmp_lg_u32 s82, 8
  s_cbranch_scc1 L_qp1
  buffer_store_dwordx4 v[28:31], v1, s[60:63], s43 offen sc1
L_qp1:
  buffer_load_dwordx4 v[64:67], v1, s[60:63], s67 offen offset:0 sc1
  buffer_load_dwordx4 v[68:71], v1, s[60:63], s67 offen offset:1024 sc1
  buffer_load_dwordx4 v[72:75], v1, s[60:63], s67 offen offset:2048 sc1
  buffer_load_dwordx4 v[76:79], v1, s[60:63], s67 offen offset:3072 sc1
  buffer_load_dwordx4 v[80:83], v39, s[60:63], s67 offen offset:0 sc1
  buffer_load_dwordx4 v[84:87], v39, s[60:63], s67 offen offset:1024 sc1
  buffer_load_dwordx4 v[88:91], v39, s[60:63], s67 offen offset:2048 sc1
  buffer_load_dwordx4 v[92:95], v39, s[60:63], s67 offen offset:3072 sc1
  s_waitcnt vmcnt(0)
  v_xor_b32 v65, v65, v58
  v_xor_b32 v67, v67, v59
  v_xor_b32 v69, v69, v58
  v_xor_b32 v71, v71, v59
  v_xor_b32 v73, v73, v58
  v_xor_b32 v75, v75, v59
  v_xor_b32 v77, v77, v58
  v_xor_b32 v79, v79, v59
  v_xor_b32 v81, v81, v58
  v_xor_b32 v83, v83, v59
  v_xor_b32 v85, v85, v58
  v_xor_b32 v87, v87, v59
  v_xor_b32 v89, v89, v58
  v_xor_b32 v91, v91, v59
  v_xor_b32 v93, v93, v58
  v_xor_b32 v95, v95, v59
  v_or3_b32 v43, v65, v69, v73
  v_or3_b32 v43, v43, v77, v81
  v_or3_b32 v43, v43, v85, v89
  v_or_b32 v43, v43, v93
  v_or3_b32 v44, v67, v71, v75
  v_or3_b32 v44, v44, v79, v83
  v_or3_b32 v44, v44, v87, v91
  v_or_b32 v44, v44, v95
  v_and_or_b32 v43, v44, -16, v43
  v_cmp_ne_u32 vcc, 0, v43
  s_cbranch_vccnz L_qpoll
  v_add_f32 v64, v64, v80
  v_add_f32 v66, v66, v82
  v_add_f32 v68, v68, v84
  v_add_f32 v70, v70, v86
  v_add_f32 v72, v72, v88
  v_add_f32 v74, v74, v90
  v_add_f32 v76, v76, v92
  v_add_f32 v78, v78, v94
  v_add_f32 v64, v64, v72
  v_add_f32 v66, v66, v74
  v_add_f32 v68, v68, v76
  v_add_f32 v70, v70, v78
  v_add_f32 v64, v64, v68
  v_add_f32 v66, v66, v70
  v_cvt_pk_bf16_f32 v64, v64, v66
  ds_write_b16 v56, v64 offset:256
  ds_write_b16_d16_hi v56, v64 offset:272
  ds_write_b32 v42, v41 offset:16
  v_mov_b32 v42, 4
  v_readfirstlane_b32 s66, v44
  s_cmp_eq_u32 s66, 0
  s_cbranch_scc1 L_nowt
  buffer_store_dwordx4 v[28:31], v1, s[60:63], s43 offen sc1
L_nowt:
  s_cmp_lg_u32 s40, 0
  s_cbranch_scc1 L_qend
  s_setprio 0
  v_mul_u32_u24 v176, 20, v0
  buffer_load_dwordx4 v[160:163], v176, s[52:55], 0 offen
  buffer_load_dword v164, v176, s[52:55], 0 offen offset:16
  buffer_load_dwordx4 v[168:171], v176, s[56:59], 0 offen
  buffer_load_dword v172, v176, s[56:59], 0 offen offset:16
  s_waitcnt vmcnt(0)
  v_mov_b32 v46, 0
  v_lshlrev_b32 v43, 16, v160
  v_lshlrev_b32 v44, 16, v168
  v_mul_f32 v43, v43, v44
  v_and_b32 v44, 0xffff0000, v160
  v_and_b32 v45, 0xffff0000, v168
  v_mul_f32 v44, v44, v45
  v_cvt_pk_bf16_f32 v43, v43, v44
  v_lshlrev_b32 v44, 16, v43
  v_and_b32 v43, 0xffff0000, v43
  v_add_f32 v46, v46, v44
  v_add_f32 v46, v46, v43
  v_lshlrev_b32 v43, 16, v161
  v_lshlrev_b32 v44, 16, v169
  v_mul_f32 v43, v43, v44
  v_and_b32 v44, 0xffff0000, v161
  v_and_b32 v45, 0xffff0000, v169
  v_mul_f32 v44, v44, v45
  v_cvt_pk_bf16_f32 v43, v43, v44
  v_lshlrev_b32 v44, 16, v43
  v_and_b32 v43, 0xffff0000, v43
  v_add_f32 v46, v46, v44
  v_add_f32 v46, v46, v43
  v_lshlrev_b32 v43, 16, v162
  v_lshlrev_b32 v44, 16, v170
  v_mul_f32 v43, v43, v44
  v_and_b32 v44, 0xffff0000, v162
  v_and_b32 v45, 0xffff0000, v170
  v_mul_f32 v44, v44, v45
  v_cvt_pk_bf16_f32 v43, v43, v44
  v_lshlrev_b32 v44, 16, v43
  v_and_b32 v43, 0xffff0000, v43
  v_add_f32 v46, v46, v44
  v_add_f32 v46, v46, v43
  v_lshlrev_b32 v43, 16, v163
  v_lshlrev_b32 v44, 16, v171
  v_mul_f32 v43, v43, v44
  v_and_b32 v44, 0xffff0000, v163
  v_and_b32 v45, 0xffff0000, v171
  v_mul_f32 v44, v44, v45
  v_cvt_pk_bf16_f32 v43, v43, v44
  v_lshlrev_b32 v44, 16, v43
  v_and_b32 v43, 0xffff0000, v43
  v_add_f32 v46, v46, v44
  v_add_f32 v46, v46, v43
  v_lshlrev_b32 v43, 16, v164
  v_lshlrev_b32 v44, 16, v172
  v_mul_f32 v43, v43, v44
  v_and_b32 v44, 0xffff0000, v164
  v_and_b32 v45, 0xffff0000, v172
  v_mul_f32 v44, v44, v45
  v_cvt_pk_bf16_f32 v43, v43, v44
  v_lshlrev_b32 v44, 16, v43
  v_and_b32 v43, 0xffff0000, v43
  v_add_f32 v46, v46, v44
  v_add_f32 v46, v46, v43
  s_nop 1
  v_add_f32_dpp v46, v46, v46 quad_perm:[1,0,3,2] row_mask:0xf bank_mask:0xf
  s_nop 1
  v_add_f32_dpp v46, v46, v46 quad_perm:[2,3,0,1] row_mask:0xf bank_mask:0xf
  s_nop 1
  v_add_f32_dpp v46, v46, v46 row_half_mirror row_mask:0xf bank_mask:0xf
  s_nop 1
  v_add_f32_dpp v46, v46, v46 row_mirror row_mask:0xf bank_mask:0xf
  s_nop 1
  v_add_f32_dpp v46, v46, v46 row_bcast:15 row_mask:0xa bank_mask:0xf
  s_nop 1
  v_add_f32_dpp v46, v46, v46 row_bcast:31 row_mask:0xc bank_mask:0xf
  v_cvt_pk_bf16_f32 v46, v46, v46
  v_and_b32 v46, 0xffff0000, v46
  v_mul_f32 v46, 0xbfb8aa3b, v46
  v_exp_f32 v46, v46
  s_nop 0
  v_add_f32 v46, 1.0, v46
  v_rcp_f32 v46, v46
  s_nop 0
  v_cvt_pk_bf16_f32 v46, v46, v46
  v_and_b32 v46, 0xffff0000, v46
  v_sub_f32 v43, 1.0, v46
  v_cvt_pk_bf16_f32 v43, v43, v43
  v_and_b32 v43, 0xffff0000, v43
  s_nop 0
  v_readlane_b32 s80, v46, 63
  v_readlane_b32 s81, v43, 63
  s_mov_b32 s40, 1
  s_add_u32 s44, s20, s41
  s_addc_u32 s45, s21, 0
  s_mov_b32 s79, s42
  s_add_u32 s67, s67, 270336
  s_add_u32 s43, s43, 270336
  v_add_u32 v56, 256, v56
  s_branch L_qloop
L_qend:
  s_sub_u32 s67, s67, 270336
  s_and_b32 s32, s2, 7
  s_lshl_b32 s32, s32, 8
  s_add_u32 s32, s32, 1200128
  s_lshr_b32 s33, s2, 3
  s_lshl_b32 s33, s33, 2
  s_add_u32 s33, s33, s32
  s_lshl_b32 s34, s64, 10
  v_lshlrev_b32 v36, 2, v0
  s_mov_b32 s40, 0
  s_mov_b32 s38, 66
  v_mov_b32 v39, v1
  v_mov_b32 v56, 0
  v_mov_b32 v47, 0
L_ct:
  s_sleep 8
  ds_read_b32 v37, v40 offset:0
  s_waitcnt lgkmcnt(0)
  v_readfirstlane_b32 s35, v37
  s_cmp_ge_u32 s35, s38
  s_cbranch_scc1 L_ce
  s_cmp_lg_u32 s66, 0
  s_cbranch_scc1 L_ct
  v_add_u32 v37, s34, v37
  s_mov_b64 exec, 1
  buffer_store_dword v37, v40, s[60:63], s33 offen
  s_mov_b32 exec_lo, -1
  buffer_load_dword v38, v36, s[60:63], s32 offen nt
  s_mov_b32 s37, 0
  s_waitcnt vmcnt(0)
  v_sub_u32 v38, v38, v37
  v_subrev_u32 v37, 0, v38
  v_cmp_gt_u32 vcc, 512, v37
  s_bcnt1_i32_b32 s36, vcc_lo
  s_cmp_ge_u32 s36, 16
  s_addc_u32 s37, s37, 0
  v_subrev_u32 v37, 2, v38
  v_cmp_gt_u32 vcc, 512, v37
  s_bcnt1_i32_b32 s36, vcc_lo
  s_cmp_ge_u32 s36, 16
  s_addc_u32 s37, s37, 0
  v_subrev_u32 v37, 4, v38
  v_cmp_gt_u32 vcc, 512, v37
  s_bcnt1_i32_b32 s36, vcc_lo
  s_cmp_ge_u32 s36, 16
  s_addc_u32 s37, s37, 0
  v_mov_b32 v37, s37
  ds_write_b32 v40, v37 offset:4
  s_mov_b64 exec, -1
  s_branch L_ct
L_ce:
  s_cmp_eq_u32 s40, 2
  s_cbranch_scc1 L_last
L_aw:
  s_sleep 2
  ds_read_b32 v37, v56 offset:24
  s_waitcnt lgkmcnt(0)
  v_readfirstlane_b32 s35, v37
  s_cmp_lt_u32 s35, 3
  s_cbranch_scc1 L_aw
  ds_read_b128 v[48:51], v47 offset:64
  ds_read_b128 v[96:99], v39 offset:25600
  ds_read_b128 v[100:103], v39 offset:26624
  ds_read_b128 v[104:107], v39 offset:27648
  ds_read_b128 v[108:111], v39 offset:28672
  ds_read_b128 v[112:115], v39 offset:29696
  ds_read_b128 v[116:119], v39 offset:30720
  ds_read_b128 v[120:123], v39 offset:31744
  ds_read_b128 v[124:127], v39 offset:32768
  s_waitcnt lgkmcnt(8)
  v_max_f32 v48, v48, v49
  v_max_f32 v48, v48, v50
  v_mul_f32 v5, v48, v4
  v_sub_f32 v5, 0, v5
  s_waitcnt lgkmcnt(0)
  v_fma_f32 v96, v96, v4, v5
  v_fma_f32 v97, v97, v4, v5
  v_fma_f32 v98, v98, v4, v5
  v_fma_f32 v99, v99, v4, v5
  v_fma_f32 v100, v100, v4, v5
  v_fma_f32 v101, v101, v4, v5
  v_fma_f32 v102, v102, v4, v5
  v_fma_f32 v103, v103, v4, v5
  v_fma_f32 v104, v104, v4, v5
  v_fma_f32 v105, v105, v4, v5
  v_fma_f32 v106, v106, v4, v5
  v_fma_f32 v107, v107, v4, v5
  v_fma_f32 v108, v108, v4, v5
  v_fma_f32 v109, v109, v4, v5
  v_fma_f32 v110, v110, v4, v5
  v_fma_f32 v111, v111, v4, v5
  v_fma_f32 v112, v112, v4, v5
  v_fma_f32 v113, v113, v4, v5
  v_fma_f32 v114, v114, v4, v5
  v_fma_f32 v115, v115, v4, v5
  v_fma_f32 v116, v116, v4, v5
  v_fma_f32 v117, v117, v4, v5
  v_fma_f32 v118, v118, v4, v5
  v_fma_f32 v119, v119, v4, v5
  v_fma_f32 v120, v120, v4, v5
  v_fma_f32 v121, v121, v4, v5
  v_fma_f32 v122, v122, v4, v5
  v_fma_f32 v123, v123, v4, v5
  v_fma_f32 v124, v124, v4, v5
  v_fma_f32 v125, v125, v4, v5
  v_fma_f32 v126, v126, v4, v5
  v_fma_f32 v127, v127, v4, v5
  v_exp_f32 v96, v96
  v_exp_f32 v97, v97
  v_exp_f32 v98, v98
  v_exp_f32 v99, v99
  v_exp_f32 v100, v100
  v_exp_f32 v101, v101
  v_exp_f32 v102, v102
  v_exp_f32 v103, v103
  v_exp_f32 v104, v104
  v_exp_f32 v105, v105
  v_exp_f32 v106, v106
  v_exp_f32 v107, v107
  v_exp_f32 v108, v108
  v_exp_f32 v109, v109
  v_exp_f32 v110, v110
  v_exp_f32 v111, v111
  v_exp_f32 v112, v112
  v_exp_f32 v113, v113
  v_exp_f32 v114, v114
  v_exp_f32 v115, v115
  v_exp_f32 v116, v116
  v_exp_f32 v117, v117
  v_exp_f32 v118, v118
  v_exp_f32 v119, v119
  v_exp_f32 v120, v120
  v_exp_f32 v121, v121
  v_exp_f32 v122, v122
  v_exp_f32 v123, v123
  v_exp_f32 v124, v124
  v_exp_f32 v125, v125
  v_exp_f32 v126, v126
  v_exp_f32 v127, v127
  v_add_f32 v96, v96, v112
  v_add_f32 v97, v97, v113
  v_add_f32 v98, v98, v114
  v_add_f32 v99, v99, v115
  v_add_f32 v100, v100, v116
  v_add_f32 v101, v101, v117
  v_add_f32 v102, v102, v118
  v_add_f32 v103, v103, v119
  v_add_f32 v104, v104, v120
  v_add_f32 v105, v105, v121
  v_add_f32 v106, v106, v122
  v_add_f32 v107, v107, v123
  v_add_f32 v108, v108, v124
  v_add_f32 v109, v109, v125
  v_add_f32 v110, v110, v126
  v_add_f32 v111, v111, v127
  v_add_f32 v96, v96, v104
  v_add_f32 v97, v97, v105
  v_add_f32 v98, v98, v106
  v_add_f32 v99, v99, v107
  v_add_f32 v100, v100, v108
  v_add_f32 v101, v101, v109
  v_add_f32 v102, v102, v110
  v_add_f32 v103, v103, v111
  v_add_f32 v96, v96, v100
  v_add_f32 v97, v97, v101
  v_add_f32 v98, v98, v102
  v_add_f32 v99, v99, v103
  v_add_f32 v96, v96, v98
  v_add_f32 v97, v97, v99
  v_add_f32 v96, v96, v97
  s_nop 1
  v_add_f32_dpp v96, v96, v96 quad_perm:[1,0,3,2] row_mask:0xf bank_mask:0xf
  s_nop 1
  v_add_f32_dpp v96, v96, v96 quad_perm:[2,3,0,1] row_mask:0xf bank_mask:0xf
  s_nop 1
  v_add_f32_dpp v96, v96, v96 row_half_mirror row_mask:0xf bank_mask:0xf
  s_nop 1
  v_add_f32_dpp v96, v96, v96 row_mirror row_mask:0xf bank_mask:0xf
  s_nop 1
  v_add_f32_dpp v96, v96, v96 row_bcast:15 row_mask:0xa bank_mask:0xf
  s_nop 1
  v_add_f32_dpp v96, v96, v96 row_bcast:31 row_mask:0xc bank_mask:0xf
  v_mov_b32 v98, v96
  v_mov_b32 v96, v5
  v_mov_b32 v97, v58
  v_mov_b32 v99, v59
  s_add_u32 s77, s67, 8192
  s_lshl_b32 s78, s73, 4
  s_add_u32 s78, s78, s77
  s_mov_b32 exec_lo, 0
  s_mov_b32 exec_hi, 0x80000000
  s_cmp_eq_u32 s66, 0
  s_cbranch_scc1 L_ml1
  buffer_store_dwordx4 v[96:99], v40, s[60:63], s78 offen sc1
  s_branch L_ml2
L_ml1:
  buffer_store_dwordx4 v[96:99], v40, s[60:63], s78 offen
L_ml2:
  s_mov_b64 exec, 0xff
L_pm:
  s_sleep 12
  buffer_load_dwordx4 v[104:107], v1, s[60:63], s77 offen sc1
  s_waitcnt vmcnt(0)
  v_xor_b32 v12, v105, v58
  v_xor_b32 v13, v107, v59
  v_and_or_b32 v12, v13, -16, v12
  v_cmp_ne_u32 vcc, 0, v12
  s_cbranch_vccnz L_pm
  v_min_f32_dpp v12, v104, v104 quad_perm:[1,0,3,2] row_mask:0xf bank_mask:0xf
  s_nop 1
  v_min_f32_dpp v12, v12, v12 quad_perm:[2,3,0,1] row_mask:0xf bank_mask:0xf
  s_nop 1
  v_min_f32_dpp v12, v12, v12 row_half_mirror row_mask:0xf bank_mask:0xf
  v_sub_f32 v13, v12, v104
  v_exp_f32 v13, v13
  v_sub_f32 v12, v12, v5
  v_exp_f32 v12, v12
  v_mul_f32 v13, v13, v106
  s_nop 1
  v_add_f32_dpp v13, v13, v13 quad_perm:[1,0,3,2] row_mask:0xf bank_mask:0xf
  s_nop 1
  v_add_f32_dpp v13, v13, v13 quad_perm:[2,3,0,1] row_mask:0xf bank_mask:0xf
  s_nop 1
  v_add_f32_dpp v13, v13, v13 row_half_mirror row_mask:0xf bank_mask:0xf
  v_rcp_f32 v13, v13
  v_mul_f32 v12, s80, v12
  v_mul_f32 v13, v13, v12
  v_min_u32 v13, -2, v13
  s_mov_b64 exec, 1
  ds_write_b32 v56, v13 offset:128
  s_mov_b64 exec, -1
  s_add_u32 s40, s40, 1
  s_cmp_eq_u32 s40, 2
  s_cbranch_scc1 L_csetup
  s_mov_b32 s80, s81
  s_add_u32 s67, s67, 270336
  s_mov_b32 s38, 194
  v_add_u32 v39, 8192, v39
  v_mov_b32 v56, 4
  v_mov_b32 v47, 16
  s_branch L_ct
L_csetup:
  s_mov_b32 s38, 254
  s_lshl_b32 s75, s72, 3
  s_add_u32 s39, s75, s73
  s_cmp_ge_u32 s39, 160
  s_cbranch_scc1 L_ct
  s_lshl_b32 s77, s39, 4
  s_add_u32 s77, s77, 4096
  s_lshr_b32 s78, s39, 2
  s_mul_i32 s75, s78, 26
  s_lshr_b32 s75, s75, 8
  s_mul_i32 s76, s75, 10
  s_sub_u32 s76, s78, s76
  s_mul_i32 s79, s75, 320
  s_and_b32 s78, s39, 3
  v_bfe_u32 v44, v0, 2, 2
  s_cmp_ge_u32 s76, 8
  s_cbranch_scc1 L_kc
  s_bfe_u32 s75, s76, 0x10001
  s_lshl_b32 s75, s75, 6
  s_add_u32 s79, s79, s75
  s_bfe_u32 s75, s76, 0x10002
  s_lshl_b32 s75, s75, 5
  s_add_u32 s79, s79, s75
  s_and_b32 s75, s76, 1
  s_lshl_b32 s75, s75, 4
  s_add_u32 s79, s79, s75
  s_lshl_b32 s75, s78, 2
  s_add_u32 s79, s79, s75
  v_and_b32 v45, 1, v44
  v_lshlrev_b32 v57, 7, v45
  v_and_b32 v45, 2, v44
  v_add_u32 v57, v57, v45
  s_branch L_kd
L_kc:
  s_lshl_b32 s75, s76, 5
  s_add_u32 s79, s79, s75
  s_lshl_b32 s75, s78, 3
  s_add_u32 s79, s79, s75
  v_lshlrev_b32 v57, 1, v44
L_kd:
  v_mul_u32_u24 v43, 10240, v0
  v_add_u32 v44, 5120, v43
  v_mov_b32 v47, 1023
  s_mov_b32 s83, 0
  s_mov_b64 s[84:85], 0
  s_mov_b64 s[86:87], 0
  s_mov_b64 s[88:89], 0
  s_mov_b64 s[90:91], 0
  s_branch L_py
L_last:
  s_setprio 2
  s_add_u32 s36, s34, 600
  v_mov_b32 v37, s36
  s_mov_b32 s83, 1
  s_mov_b32 s37, 64
  s_mov_b64 s[84:85], -1
  s_mov_b64 s[86:87], -1
  s_mov_b64 s[88:89], -1
  s_mov_b64 s[90:91], -1
  s_cmp_lt_u32 s39, 160
  s_cbranch_scc1 L_cons
  s_waitcnt lgkmcnt(0)
  s_barrier
  s_barrier
  s_mov_b64 exec, 1
  buffer_store_dword v37, v40, s[60:63], s33 offen
  s_branch L_fin
L_cons:
  s_waitcnt lgkmcnt(0)
  s_barrier
  s_mov_b64 exec, 1
  s_mov_b32 exec_lo, -1
  s_mov_b32 s35, 0
  s_barrier
  s_mov_b64 exec, 1
  buffer_store_dword v37, v40, s[60:63], s33 offen
  s_mov_b32 exec_lo, -1
L_hw:
  buffer_load_dword v38, v36, s[60:63], s32 offen nt
  s_add_u32 s35, s35, 1
  s_waitcnt vmcnt(0)
  v_cmp_eq_u32 vcc, v38, v37
  s_bcnt1_i32_b32 s36, vcc_lo
  s_cmp_ge_u32 s36, 28
  s_cbranch_scc1 L_py
  s_cmp_lt_u32 s35, 24
  s_cbranch_scc1 L_hw
L_py:
  s_mov_b64 exec, s[84:85]
  s_cbranch_execz L_sk0
  buffer_load_dwordx4 v[64:67], v43, s[60:63], s77 offen offset:0 sc1
L_sk0:
  s_mov_b64 exec, s[86:87]
  s_cbranch_execz L_sk1
  buffer_load_dwordx4 v[68:71], v43, s[60:63], s77 offen offset:2560 sc1
L_sk1:
  s_mov_b64 exec, s[88:89]
  s_cbranch_execz L_sk2
  buffer_load_dwordx4 v[72:75], v44, s[60:63], s77 offen offset:0 sc1
L_sk2:
  s_mov_b64 exec, s[90:91]
  s_cbranch_execz L_sk3
  buffer_load_dwordx4 v[76:79], v44, s[60:63], s77 offen offset:2560 sc1
L_sk3:
  s_mov_b64 exec, -1
  s_waitcnt vmcnt(0)
L_chk:
  v_xor_b32 v128, v64, v60
  v_xor_b32 v129, v65, v61
  v_xor_b32 v130, v66, v62
  v_xor_b32 v131, v67, v63
  v_xor_b32 v132, v68, v60
  v_xor_b32 v133, v69, v61
  v_xor_b32 v134, v70, v62
  v_xor_b32 v135, v71, v63
  v_xor_b32 v136, v72, v60
  v_xor_b32 v137, v73, v61
  v_xor_b32 v138, v74, v62
  v_xor_b32 v139, v75, v63
  v_xor_b32 v140, v76, v60
  v_xor_b32 v141, v77, v61
  v_xor_b32 v142, v78, v62
  v_xor_b32 v143, v79, v63
  v_or3_b32 v12, v128, v129, v130
  v_or3_b32 v13, v132, v133, v134
  v_or3_b32 v14, v136, v137, v138
  v_or3_b32 v15, v140, v141, v142
  v_bitop3_b32 v12, v12, v131, v47 bitop3:0xa8
  v_bitop3_b32 v13, v13, v135, v47 bitop3:0xa8
  v_bitop3_b32 v14, v14, v139, v47 bitop3:0xa8
  v_bitop3_b32 v15, v15, v143, v47 bitop3:0xa8
  v_cmp_ne_u32 s[84:85], 0, v12
  v_cmp_ne_u32 s[86:87], 0, v13
  v_cmp_ne_u32 s[88:89], 0, v14
  v_cmp_ne_u32 s[90:91], 0, v15
  v_add_f32 v80, v128, v132
  v_add_f32 v84, v136, v140
  v_add_f32 v81, v129, v133
  v_add_f32 v85, v137, v141
  v_add_f32 v82, v130, v134
  v_add_f32 v86, v138, v142
  v_add_f32 v83, v131, v135
  v_add_f32 v87, v139, v143
  s_or_b64 s[92:93], s[84:85], s[86:87]
  s_or_b64 vcc, s[88:89], s[90:91]
  s_or_b64 s[92:93], s[92:93], vcc
  s_bcnt1_i32_b64 s37, s[92:93]
  s_cbranch_scc0 L_yok
  s_cmp_lg_u32 s83, 0
  s_cbranch_scc1 L_py
L_yok:
  v_add_f32 v80, v80, v84
  v_add_f32 v81, v81, v85
  v_add_f32 v82, v82, v86
  v_add_f32 v83, v83, v87
  v_add_f32_dpp v80, v80, v80 row_ror:8 row_mask:0xf bank_mask:0x3
  v_add_f32_dpp v81, v81, v81 row_ror:8 row_mask:0xf bank_mask:0x3
  v_add_f32_dpp v80, v82, v82 row_ror:8 row_mask:0xf bank_mask:0xc
  v_add_f32_dpp v81, v83, v83 row_ror:8 row_mask:0xf bank_mask:0xc
  s_nop 0
  v_add_f32_dpp v80, v80, v80 row_half_mirror row_mask:0xf bank_mask:0x5
  v_add_f32_dpp v80, v81, v81 row_half_mirror row_mask:0xf bank_mask:0xa
  s_nop 1
  v_add_f32_dpp v80, v80, v80 quad_perm:[1,0,3,2] row_mask:0xf bank_mask:0xf
  s_nop 1
  v_add_f32_dpp v80, v80, v80 quad_perm:[2,3,0,1] row_mask:0xf bank_mask:0xf
  v_mov_b32 v81, v80
  s_nop 1
  v_permlane16_swap_b32 v80, v81
  s_nop 0
  v_add_f32 v80, v80, v81
  v_mov_b32 v81, v80
  s_nop 1
  v_permlane32_swap_b32 v80, v81
  s_nop 0
  v_add_f32 v80, v80, v81
  v_cvt_pk_bf16_f32 v80, v80, v80
  s_cmp_eq_u32 s83, 0
  s_cbranch_scc1 L_ct
  s_mov_b32 exec_lo, 0x1111
  s_mov_b32 exec_hi, 0
  buffer_store_short v80, v57, s[68:71], s79 offen
  s_cmp_lg_u32 s2, 0
  s_cbranch_scc1 L_fin
  s_mov_b64 exec, 1
  s_mov_b32 s75, 0
  buffer_store_dwordx2 v[58:59], v40, s[60:63], s75 offen
L_fin:
L_end:
  s_endpgm
  .fill (20480 - (. - gated_mix__gqa_block_cached__gqa_block_cached__decode_kernel)) / 4, 4, 0xbf800000
.section .rodata,"a"
.p2align 6
.amdhsa_kernel gated_mix__gqa_block_cached__gqa_block_cached__decode_kernel
  .amdhsa_next_free_vgpr 256
  .amdhsa_next_free_sgpr 100
  .amdhsa_accum_offset 256
  .amdhsa_group_segment_fixed_size 0
  .amdhsa_kernarg_size 112
  .amdhsa_user_sgpr_count 2
  .amdhsa_user_sgpr_kernarg_segment_ptr 1
  .amdhsa_system_sgpr_workgroup_id_x 1
  .amdhsa_float_denorm_mode_32 3
.end_amdhsa_kernel
```
